```python
import torch

def _softmax(x, axis=-1):
    return torch.softmax(x, dim=axis)

def _gelu(x):
    return torch.nn.functional.gelu(x, approximate='tanh')

def _silu(x):
    return torch.nn.functional.silu(x)

def _sigmoid(x):
    return torch.sigmoid(x)

def _layernorm(x, axis=-1, eps=1e-05):
    m = x.mean(dim=axis, keepdim=True)
    v = x.var(dim=axis, keepdim=True, unbiased=False)
    return (x - m) / torch.sqrt(v + eps)

def _scatter_add(tgt, idx, src, axis=0):
    return tgt.clone().index_add_(axis, idx, src)

def _segment_sum(src, seg, n):
    out = torch.zeros((n,) + src.shape[1:], dtype=src.dtype)
    return out.index_add_(0, seg, src)

def _pad(x, pw):
    flat = tuple((v for pair in reversed(pw) for v in pair))
    return torch.nn.functional.pad(x, flat)
kernel_name = 'adaLN_cond__gqa_block_cached__dense_activation_relu__decode'

def setup_inputs():

    _w = lambda a: (lambda t: t.to(torch.bfloat16) if t.is_floating_point() else t)(torch.as_tensor(a))

    def _A_setup():
        B, Sq, D = (1, 1, 576)
        Hq, Hkv, Sk, Dh = (32, 16, 65536, 128)
        assert Hq % Hkv == 0, (Hq, Hkv)
        return {'x': _w((lambda *s: torch.randn(*s, dtype=torch.bfloat16) * 0.1)(B, Sq, D)), 'k_cache': _w((lambda *s: torch.randn(*s, dtype=torch.bfloat16) * 0.8)(B, Hkv, Sk, Dh)), 'v_cache': _w((lambda *s: torch.randn(*s, dtype=torch.bfloat16) * 0.8)(B, Hkv, Sk, Dh)), 'wq': _w((lambda *s: torch.randn(*s, dtype=torch.bfloat16) * 0.8)(D, Hq * Dh) * D ** (-0.5)), 'wo': _w((lambda *s: torch.randn(*s, dtype=torch.bfloat16) * 0.8)(Hq * Dh, D) * (Hq * Dh) ** (-0.5))}
    _A_in = _A_setup()

    def _B_setup():
        B, S, D, Dff = (1, 1, 576, 4608)
        return {'x': _w((lambda *s: torch.randn(*s, dtype=torch.bfloat16) * 0.1)(B, S, D)), 'w1': _w((lambda *s: torch.randn(*s, dtype=torch.bfloat16) * 0.1)(D, Dff)), 'w2': _w((lambda *s: torch.randn(*s, dtype=torch.bfloat16) * 0.1)(Dff, D))}
    _B_in = _B_setup()
    return {'A_x': _A_in['x'], 'A_k_cache': _A_in['k_cache'], 'A_v_cache': _A_in['v_cache'], 'A_wq': _A_in['wq'], 'A_wo': _A_in['wo'], 'B_x': _B_in['x'], 'B_w1': _B_in['w1'], 'B_w2': _B_in['w2'], 'c': _w((lambda *s: torch.randn(*s, dtype=torch.bfloat16) * 0.4)(1, 576) * 8.0), 'w_mod': _w((lambda *s: torch.randn(*s, dtype=torch.bfloat16) * 0.4)(576, 6 * 576) * 576 ** (-0.5) * 8.0)}

def reference(A_x, A_k_cache, A_v_cache, A_wq, A_wo, B_x, B_w1, B_w2, c, w_mod):

    def _A_ref(x, k_cache, v_cache, wq, wo):
        B, Sq, D = x.shape
        Hq, Dh = (32, 128)
        Hkv = k_cache.shape[1]
        rep = Hq // Hkv
        q = (lambda x, *d: x.permute(*d))((x @ wq).reshape(B, Sq, Hq, Dh), 0, 2, 1, 3)
        k = (lambda x, n, axis: torch.repeat_interleave(x, n, dim=axis))(k_cache, rep, axis=1)
        v = (lambda x, n, axis: torch.repeat_interleave(x, n, dim=axis))(v_cache, rep, axis=1)
        scores = torch.einsum('bhqd,bhkd->bhqk', q, k) * Dh ** (-0.5)
        p = _softmax(scores, axis=-1)
        o = torch.einsum('bhqk,bhkd->bhqd', p, v)
        return (lambda x, *d: x.permute(*d))(o, 0, 2, 1, 3).reshape(B, Sq, Hq * Dh) @ wo

    def _B_ref(x, w1, w2):
        h = torch.einsum('bsd,df->bsf', x, w1)
        zero = torch.zeros_like(h)
        h = torch.maximum(h, zero)
        return torch.einsum('bsf,fd->bsd', h, w2)
    x = A_x
    mod = (_silu(c) @ w_mod).reshape(c.shape[0], 6, 1, -1)
    sa, ca, ga, sb, cb, gb = (mod[:, 0].clone(), mod[:, 1].clone(), mod[:, 2].clone(), mod[:, 3].clone(), mod[:, 4].clone(), mod[:, 5].clone())
    h = _layernorm(x, axis=-1) * (1 + ca) + sa
    x = x + ga * _A_ref(h, A_k_cache, A_v_cache, A_wq, A_wo)
    h = _layernorm(x, axis=-1) * (1 + cb) + sb
    x = x + gb * _B_ref(h, B_w1, B_w2)
    return x
```

```asm
; @launch grid=(256,1,1) block=(512,1,1) lds=159744
.amdgcn_target "amdgcn-amd-amdhsa--gfx950"
.text
.globl adaLN_cond__gqa_block_cached__dense_activation_relu__decode_kernel
.p2align 8
.type adaLN_cond__gqa_block_cached__dense_activation_relu__decode_kernel,@function
adaLN_cond__gqa_block_cached__dense_activation_relu__decode_kernel:
    s_load_dwordx2 s[8:9], s[0:1], 8
    s_cmpk_ge_u32 s2, 0x100
    s_cbranch_scc1 L_end
    v_readfirstlane_b32 s3, v0
    v_and_b32 v1, 12, v0
    v_and_b32 v3, 48, v0
    v_and_b32 v4, 3, v0
    s_cmpk_ge_u32 s3, 0x100
    s_cbranch_scc1 L_service
    v_lshlrev_b32 v1, 6, v1
    v_lshl_or_b32 v1, v3, 2, v1
    v_lshl_or_b32 v2, v4, 4, v1
    s_lshr_b32 s15, s2, 4
    s_lshl_b32 s15, s15, 8
    s_or_b32 s15, s15, s3
    s_lshl_b32 s15, s15, 5
    s_and_b32 s30, s2, 8
    s_lshl_b32 s30, s30, 21
    s_and_b32 s14, s2, 7
    s_lshl_b32 s14, s14, 25
    s_or_b32 s30, s30, s14
    s_or_b32 s30, s30, s15
    s_brev_b32 s10, 8
    s_mov_b32 s11, 0x20000
    s_waitcnt lgkmcnt(0)
    buffer_load_dwordx4 v[64:67], v2, s[8:11], s30 offen offset:0 nt
    buffer_load_dwordx4 v[68:71], v2, s[8:11], s30 offen offset:1024 nt
    s_xor_b32 s15, s30, 0x200000
    buffer_load_dwordx4 v[72:75], v2, s[8:11], s15 offen offset:0 nt
    buffer_load_dwordx4 v[76:79], v2, s[8:11], s15 offen offset:1024 nt
    s_xor_b32 s15, s30, 0x400000
    buffer_load_dwordx4 v[80:83], v2, s[8:11], s15 offen offset:0 nt
    s_setprio 1
    s_mov_b32 s14, 0
    s_waitcnt vmcnt(4)
    buffer_load_dwordx4 v[84:87], v2, s[8:11], s15 offen offset:1024 nt
    s_xor_b32 s15, s30, 0x600000
    s_waitcnt vmcnt(4)
    buffer_load_dwordx4 v[88:91], v2, s[8:11], s15 offen offset:0 nt
    s_waitcnt vmcnt(4)
    buffer_load_dwordx4 v[92:95], v2, s[8:11], s15 offen offset:1024 nt
    s_add_u32 s14, s14, 1
    s_bfe_u32 s15, s14, 0x10000
    s_lshl_b32 s15, s15, 23
    s_xor_b32 s16, s30, s15
    s_bfe_u32 s15, s14, 0x40001
    s_lshl_b32 s15, s15, 17
    s_xor_b32 s16, s16, s15
    s_barrier
    s_waitcnt vmcnt(4)
    buffer_load_dwordx4 v[96:99], v2, s[8:11], s16 offen offset:0 nt
    s_waitcnt vmcnt(4)
    buffer_load_dwordx4 v[100:103], v2, s[8:11], s16 offen offset:1024 nt
    s_xor_b32 s15, s16, 0x200000
    s_waitcnt vmcnt(4)
    buffer_load_dwordx4 v[104:107], v2, s[8:11], s15 offen offset:0 nt
    s_waitcnt vmcnt(4)
    buffer_load_dwordx4 v[108:111], v2, s[8:11], s15 offen offset:1024 nt
    s_xor_b32 s15, s16, 0x400000
    s_waitcnt vmcnt(4)
    buffer_load_dwordx4 v[112:115], v2, s[8:11], s15 offen offset:0 nt
    s_waitcnt vmcnt(4)
    buffer_load_dwordx4 v[116:119], v2, s[8:11], s15 offen offset:1024 nt
    s_xor_b32 s15, s16, 0x600000
    s_waitcnt vmcnt(4)
    buffer_load_dwordx4 v[120:123], v2, s[8:11], s15 offen offset:0 nt
    s_waitcnt vmcnt(4)
    buffer_load_dwordx4 v[124:127], v2, s[8:11], s15 offen offset:1024 nt
    s_add_u32 s14, s14, 1
    s_bfe_u32 s15, s14, 0x10000
    s_lshl_b32 s15, s15, 23
    s_xor_b32 s16, s30, s15
    s_bfe_u32 s15, s14, 0x40001
    s_lshl_b32 s15, s15, 17
    s_xor_b32 s16, s16, s15
    s_waitcnt vmcnt(4)
    buffer_load_dwordx4 v[128:131], v2, s[8:11], s16 offen offset:0 nt
    s_waitcnt vmcnt(4)
    buffer_load_dwordx4 v[132:135], v2, s[8:11], s16 offen offset:1024 nt
    s_xor_b32 s15, s16, 0x200000
    s_waitcnt vmcnt(4)
    buffer_load_dwordx4 v[136:139], v2, s[8:11], s15 offen offset:0 nt
    s_waitcnt vmcnt(4)
    buffer_load_dwordx4 v[140:143], v2, s[8:11], s15 offen offset:1024 nt
    s_load_dwordx2 s[24:25], s[0:1], 96
    s_load_dwordx2 s[12:13], s[0:1], 16
    v_and_b32 v0, 63, v0
    s_lshr_b32 s3, s3, 6
    s_mov_b32 s19, 0x3fb8aa3b
    s_and_b32 s34, s2, 7
    s_lshl_b32 s34, s34, 5
    s_and_b32 s17, s2, 8
    s_lshl_b32 s17, s17, 1
    s_or_b32 s34, s34, s17
    s_lshr_b32 s17, s2, 4
    s_or_b32 s34, s34, s17
    s_mov_b32 s18, 0x3db504f3
    v_lshlrev_b32 v4, 4, v0
    v_and_b32 v1, 1, v0
    v_cmp_eq_u32 vcc, 1, v1
    v_mov_b32 v6, 0xffff
    v_mov_b32 v11, 0xffff0000
    v_cndmask_b32 v6, v6, v11, vcc
    v_mov_b32 v7, 0xff800000
    s_xor_b32 s15, s16, 0x400000
    s_waitcnt vmcnt(4)
    buffer_load_dwordx4 v[144:147], v2, s[8:11], s15 offen offset:0 nt
    s_waitcnt vmcnt(4)
    buffer_load_dwordx4 v[148:151], v2, s[8:11], s15 offen offset:1024 nt
    v_mov_b32 v24, 0
    v_mov_b32 v25, 0
    v_mov_b32 v26, 0
    v_mov_b32 v27, 0
    v_mov_b32 v28, 0
    v_mov_b32 v29, 0
    v_mov_b32 v30, 0
    v_mov_b32 v31, 0
    v_mov_b32 v32, 0
    v_mov_b32 v33, 0
    v_mov_b32 v34, 0
    v_mov_b32 v35, 0
    v_lshlrev_b32 v1, 8, v1
    v_lshrrev_b32 v11, 2, v0
    v_lshl_add_u32 v13, v11, 4, v1
    s_xor_b32 s15, s16, 0x600000
    s_waitcnt vmcnt(4)
    buffer_load_dwordx4 v[152:155], v2, s[8:11], s15 offen offset:0 nt
    s_waitcnt vmcnt(4)
    buffer_load_dwordx4 v[156:159], v2, s[8:11], s15 offen offset:1024 nt
    s_add_u32 s14, s14, 1
    s_bfe_u32 s15, s14, 0x10000
    s_lshl_b32 s15, s15, 23
    s_xor_b32 s16, s30, s15
    s_bfe_u32 s15, s14, 0x40001
    s_lshl_b32 s15, s15, 17
    s_xor_b32 s16, s16, s15
    s_lshl_b32 s20, s3, 12
    s_add_u32 s20, s20, 12288
    v_lshl_add_u32 v14, v0, 1, s20
    s_mul_i32 s21, s3, 32768
    s_add_u32 s21, s21, 28672
    v_add_u32 v58, s21, v4
    v_mov_b32 v56, 0
    v_mov_b32 v57, 0
    s_mov_b32 s26, 2097152
    s_mov_b32 s27, 0x20000
    s_waitcnt lgkmcnt(0)
    s_load_dword s35, s[24:25], 0
    s_waitcnt vmcnt(4)
    buffer_load_dwordx4 v[160:163], v2, s[8:11], s16 offen offset:0 nt
    s_waitcnt vmcnt(4)
    buffer_load_dwordx4 v[164:167], v2, s[8:11], s16 offen offset:1024 nt
    s_xor_b32 s15, s16, 0x200000
    s_waitcnt vmcnt(4)
    buffer_load_dwordx4 v[168:171], v2, s[8:11], s15 offen offset:0 nt
    s_waitcnt vmcnt(4)
    buffer_load_dwordx4 v[172:175], v2, s[8:11], s15 offen offset:1024 nt
    s_xor_b32 s15, s16, 0x400000
    s_waitcnt vmcnt(4)
    buffer_load_dwordx4 v[176:179], v2, s[8:11], s15 offen offset:0 nt
    s_waitcnt vmcnt(4)
    buffer_load_dwordx4 v[180:183], v2, s[8:11], s15 offen offset:1024 nt
    s_xor_b32 s15, s16, 0x600000
    s_waitcnt vmcnt(4)
    buffer_load_dwordx4 v[184:187], v2, s[8:11], s15 offen offset:0 nt
    s_waitcnt vmcnt(4)
    buffer_load_dwordx4 v[188:191], v2, s[8:11], s15 offen offset:1024 nt
    s_add_u32 s14, s14, 1
    s_bfe_u32 s15, s14, 0x10000
    s_lshl_b32 s15, s15, 23
    s_xor_b32 s16, s30, s15
    s_bfe_u32 s15, s14, 0x40001
    s_lshl_b32 s15, s15, 17
    s_xor_b32 s16, s16, s15
    s_waitcnt vmcnt(4)
    buffer_load_dwordx4 v[192:195], v2, s[8:11], s16 offen offset:0 nt
    s_waitcnt vmcnt(4)
    buffer_load_dwordx4 v[196:199], v2, s[8:11], s16 offen offset:1024 nt
    s_xor_b32 s15, s16, 0x200000
    s_waitcnt vmcnt(4)
    buffer_load_dwordx4 v[200:203], v2, s[8:11], s15 offen offset:0 nt
    s_waitcnt vmcnt(4)
    buffer_load_dwordx4 v[204:207], v2, s[8:11], s15 offen offset:1024 nt
    s_xor_b32 s15, s16, 0x400000
    s_waitcnt vmcnt(4)
    buffer_load_dwordx4 v[208:211], v2, s[8:11], s15 offen offset:0 nt
    s_waitcnt vmcnt(4)
    buffer_load_dwordx4 v[212:215], v2, s[8:11], s15 offen offset:1024 nt
    s_xor_b32 s15, s16, 0x600000
    s_waitcnt vmcnt(4)
    buffer_load_dwordx4 v[216:219], v2, s[8:11], s15 offen offset:0 nt
    s_waitcnt vmcnt(4)
    buffer_load_dwordx4 v[220:223], v2, s[8:11], s15 offen offset:1024 nt
    s_add_u32 s14, s14, 1
    s_bfe_u32 s15, s14, 0x10000
    s_lshl_b32 s15, s15, 23
    s_xor_b32 s16, s30, s15
    s_bfe_u32 s15, s14, 0x40001
    s_lshl_b32 s15, s15, 17
    s_xor_b32 s16, s16, s15
    v_mov_b32 v1, 5
    ds_write_b32 v56, v1 offset:60
    s_waitcnt vmcnt(4)
    buffer_load_dwordx4 v[224:227], v2, s[8:11], s16 offen offset:0 nt
    s_waitcnt vmcnt(4)
    buffer_load_dwordx4 v[228:231], v2, s[8:11], s16 offen offset:1024 nt
    s_xor_b32 s15, s16, 0x200000
    s_waitcnt vmcnt(4)
    buffer_load_dwordx4 v[232:235], v2, s[8:11], s15 offen offset:0 nt
    s_waitcnt vmcnt(4)
    buffer_load_dwordx4 v[236:239], v2, s[8:11], s15 offen offset:1024 nt
    s_xor_b32 s15, s16, 0x400000
    s_waitcnt vmcnt(4)
    buffer_load_dwordx4 v[240:243], v2, s[8:11], s15 offen offset:0 nt
    s_waitcnt vmcnt(4)
    buffer_load_dwordx4 v[244:247], v2, s[8:11], s15 offen offset:1024 nt
    s_xor_b32 s15, s16, 0x600000
    s_waitcnt vmcnt(4)
    buffer_load_dwordx4 v[248:251], v2, s[8:11], s15 offen offset:0 nt
    s_waitcnt vmcnt(4)
    buffer_load_dwordx4 v[252:255], v2, s[8:11], s15 offen offset:1024 nt
    s_add_u32 s14, s14, 1
    s_bfe_u32 s15, s14, 0x10000
    s_lshl_b32 s15, s15, 23
    s_xor_b32 s16, s30, s15
    s_bfe_u32 s15, s14, 0x40001
    s_lshl_b32 s15, s15, 17
    s_xor_b32 s16, s16, s15
    s_add_u32 m0, s21, 0
    s_waitcnt vmcnt(4)
    buffer_load_dwordx4 v2, s[8:11], s16 offen offset:0 nt lds
    s_waitcnt vmcnt(4)
    buffer_load_dwordx4 v2, s[8:11], s16 offen offset:1024 nt lds
    s_add_u32 m0, s21, 2048
    s_xor_b32 s15, s16, 0x200000
    s_waitcnt vmcnt(4)
    buffer_load_dwordx4 v2, s[8:11], s15 offen offset:0 nt lds
    s_waitcnt vmcnt(4)
    buffer_load_dwordx4 v2, s[8:11], s15 offen offset:1024 nt lds
    s_add_u32 m0, s21, 4096
    s_xor_b32 s15, s16, 0x400000
    s_waitcnt vmcnt(4)
    buffer_load_dwordx4 v2, s[8:11], s15 offen offset:0 nt lds
    s_waitcnt vmcnt(4)
    buffer_load_dwordx4 v2, s[8:11], s15 offen offset:1024 nt lds
    s_add_u32 m0, s21, 6144
    s_xor_b32 s15, s16, 0x600000
    s_waitcnt vmcnt(4)
    buffer_load_dwordx4 v2, s[8:11], s15 offen offset:0 nt lds
    s_waitcnt vmcnt(4)
    buffer_load_dwordx4 v2, s[8:11], s15 offen offset:1024 nt lds
    s_add_u32 s14, s14, 1
    s_bfe_u32 s15, s14, 0x10000
    s_lshl_b32 s15, s15, 23
    s_xor_b32 s16, s30, s15
    s_bfe_u32 s15, s14, 0x40001
    s_lshl_b32 s15, s15, 17
    s_xor_b32 s16, s16, s15
    s_add_u32 m0, s21, 8192
    s_waitcnt vmcnt(4)
    buffer_load_dwordx4 v2, s[8:11], s16 offen offset:0 nt lds
    s_waitcnt vmcnt(4)
    buffer_load_dwordx4 v2, s[8:11], s16 offen offset:1024 nt lds
    s_add_u32 m0, s21, 10240
    s_xor_b32 s15, s16, 0x200000
    s_waitcnt vmcnt(4)
    buffer_load_dwordx4 v2, s[8:11], s15 offen offset:0 nt lds
    s_waitcnt vmcnt(4)
    buffer_load_dwordx4 v2, s[8:11], s15 offen offset:1024 nt lds
    s_add_u32 m0, s21, 12288
    s_xor_b32 s15, s16, 0x400000
    s_waitcnt vmcnt(4)
    buffer_load_dwordx4 v2, s[8:11], s15 offen offset:0 nt lds
    s_waitcnt vmcnt(4)
    buffer_load_dwordx4 v2, s[8:11], s15 offen offset:1024 nt lds
    s_add_u32 m0, s21, 14336
    s_xor_b32 s15, s16, 0x600000
    s_waitcnt vmcnt(4)
    buffer_load_dwordx4 v2, s[8:11], s15 offen offset:0 nt lds
    s_waitcnt vmcnt(4)
    buffer_load_dwordx4 v2, s[8:11], s15 offen offset:1024 nt lds
    s_add_u32 s14, s14, 1
    s_bfe_u32 s15, s14, 0x10000
    s_lshl_b32 s15, s15, 23
    s_xor_b32 s16, s30, s15
    s_bfe_u32 s15, s14, 0x40001
    s_lshl_b32 s15, s15, 17
    s_xor_b32 s16, s16, s15
    v_mov_b32 v1, 8
    ds_write_b32 v56, v1 offset:60
    s_add_u32 m0, s21, 16384
    s_waitcnt vmcnt(4)
    buffer_load_dwordx4 v2, s[8:11], s16 offen offset:0 nt lds
    s_waitcnt vmcnt(4)
    buffer_load_dwordx4 v2, s[8:11], s16 offen offset:1024 nt lds
    s_add_u32 m0, s21, 18432
    s_xor_b32 s15, s16, 0x200000
    s_waitcnt vmcnt(4)
    buffer_load_dwordx4 v2, s[8:11], s15 offen offset:0 nt lds
    s_waitcnt vmcnt(4)
    buffer_load_dwordx4 v2, s[8:11], s15 offen offset:1024 nt lds
    s_add_u32 m0, s21, 20480
    s_xor_b32 s15, s16, 0x400000
    s_waitcnt vmcnt(4)
    buffer_load_dwordx4 v2, s[8:11], s15 offen offset:0 nt lds
    s_waitcnt vmcnt(4)
    buffer_load_dwordx4 v2, s[8:11], s15 offen offset:1024 nt lds
    s_add_u32 m0, s21, 22528
    s_xor_b32 s15, s16, 0x600000
    s_waitcnt vmcnt(4)
    buffer_load_dwordx4 v2, s[8:11], s15 offen offset:0 nt lds
    s_waitcnt vmcnt(4)
    buffer_load_dwordx4 v2, s[8:11], s15 offen offset:1024 nt lds
    s_add_u32 s14, s14, 1
    s_bfe_u32 s15, s14, 0x10000
    s_lshl_b32 s15, s15, 23
    s_xor_b32 s16, s30, s15
    s_bfe_u32 s15, s14, 0x40001
    s_lshl_b32 s15, s15, 17
    s_xor_b32 s16, s16, s15
    s_add_u32 m0, s21, 24576
    s_waitcnt vmcnt(4)
    buffer_load_dwordx4 v2, s[8:11], s16 offen offset:0 nt lds
    s_waitcnt vmcnt(4)
    buffer_load_dwordx4 v2, s[8:11], s16 offen offset:1024 nt lds
    s_add_u32 m0, s21, 26624
    s_xor_b32 s15, s16, 0x200000
    s_waitcnt vmcnt(4)
    buffer_load_dwordx4 v2, s[8:11], s15 offen offset:0 nt lds
    s_waitcnt vmcnt(4)
    buffer_load_dwordx4 v2, s[8:11], s15 offen offset:1024 nt lds
    s_add_u32 m0, s21, 28672
    s_xor_b32 s15, s16, 0x400000
    s_waitcnt vmcnt(4)
    buffer_load_dwordx4 v2, s[8:11], s15 offen offset:0 nt lds
    s_waitcnt vmcnt(4)
    buffer_load_dwordx4 v2, s[8:11], s15 offen offset:1024 nt lds
    s_add_u32 m0, s21, 30720
    s_xor_b32 s15, s16, 0x600000
    s_waitcnt vmcnt(4)
    buffer_load_dwordx4 v2, s[8:11], s15 offen offset:0 nt lds
    s_waitcnt vmcnt(4)
    buffer_load_dwordx4 v2, s[8:11], s15 offen offset:1024 nt lds
    s_add_u32 s14, s14, 1
    s_bfe_u32 s15, s14, 0x10000
    s_lshl_b32 s15, s15, 23
    s_xor_b32 s16, s30, s15
    s_bfe_u32 s15, s14, 0x40001
    s_lshl_b32 s15, s15, 17
    s_xor_b32 s16, s16, s15
L_qwait:
    ds_read_b32 v1, v56 offset:224
    ds_read_b128 v[16:19], v13 offset:256
    s_waitcnt lgkmcnt(0)
    v_cmp_eq_u32 vcc, 0, v1
    s_cbranch_vccnz L_qwait
    v_and_b32 v1, 2, v0
    v_cmp_eq_u32 vcc, 0, v1
    s_mov_b32 s17, 11
    s_nop 0
    v_cndmask_b32 v20, v16, 0, vcc
    v_cndmask_b32 v21, v17, 0, vcc
    v_cndmask_b32 v22, v18, 0, vcc
    v_cndmask_b32 v23, v19, 0, vcc
    v_cndmask_b32 v16, 0, v16, vcc
    v_cndmask_b32 v17, 0, v17, vcc
    v_cndmask_b32 v18, 0, v18, vcc
    v_cndmask_b32 v19, 0, v19, vcc
    s_nop 1
    v_mfma_f32_16x16x32_bf16 v[36:39], v[64:67], v[16:19], 0
    v_mfma_f32_16x16x32_bf16 v[36:39], v[68:71], v[20:23], v[36:39]
    v_mfma_f32_16x16x32_bf16 v[40:43], v[72:75], v[16:19], 0
    v_mfma_f32_16x16x32_bf16 v[40:43], v[76:79], v[20:23], v[40:43]
    v_mfma_f32_16x16x32_bf16 v[44:47], v[80:83], v[16:19], 0
    v_mfma_f32_16x16x32_bf16 v[44:47], v[84:87], v[20:23], v[44:47]
    v_mfma_f32_16x16x32_bf16 v[48:51], v[88:91], v[16:19], 0
    v_mfma_f32_16x16x32_bf16 v[48:51], v[92:95], v[20:23], v[48:51]
    s_nop 1
    v_add_f32_dpp v52, v37, v36 row_ror:12 row_mask:0xf bank_mask:0xf
    s_nop 0
    v_add_f32_dpp v53, v42, v41 row_ror:12 row_mask:0xf bank_mask:0xf
    s_nop 0
    v_add_f32_dpp v54, v47, v46 row_ror:12 row_mask:0xf bank_mask:0xf
    s_nop 0
    v_add_f32_dpp v55, v48, v51 row_ror:12 row_mask:0xf bank_mask:0xf
    v_add_f32_dpp v52, v38, v52 row_ror:8 row_mask:0xf bank_mask:0xf
    v_add_f32_dpp v53, v43, v53 row_ror:8 row_mask:0xf bank_mask:0xf
    v_add_f32_dpp v54, v44, v54 row_ror:8 row_mask:0xf bank_mask:0xf
    v_add_f32_dpp v55, v49, v55 row_ror:8 row_mask:0xf bank_mask:0xf
    v_add_f32_dpp v9, v39, v52 row_ror:4 row_mask:0xf bank_mask:0x1
    s_nop 1
    v_add_f32_dpp v9, v40, v53 row_ror:4 row_mask:0xf bank_mask:0x2
    s_nop 1
    v_add_f32_dpp v9, v45, v54 row_ror:4 row_mask:0xf bank_mask:0x4
    s_nop 1
    v_add_f32_dpp v9, v50, v55 row_ror:4 row_mask:0xf bank_mask:0x8
    v_cvt_pk_bf16_f32 v9, 0, v9
    v_mul_f32 v9, s18, v9
    v_cvt_pk_bf16_f32 v10, 0, v9
    v_max_f32 v7, v7, v10
    ds_write_b16_d16_hi v14, v10 offset:0
    s_waitcnt vmcnt(4)
    buffer_load_dwordx4 v[64:67], v2, s[8:11], s16 offen offset:0 nt
    s_waitcnt vmcnt(4)
    buffer_load_dwordx4 v[68:71], v2, s[8:11], s16 offen offset:1024 nt
    v_mfma_f32_16x16x32_bf16 v[36:39], v[96:99], v[16:19], 0
    v_mfma_f32_16x16x32_bf16 v[36:39], v[100:103], v[20:23], v[36:39]
    v_mfma_f32_16x16x32_bf16 v[40:43], v[104:107], v[16:19], 0
    v_mfma_f32_16x16x32_bf16 v[40:43], v[108:111], v[20:23], v[40:43]
    v_mfma_f32_16x16x32_bf16 v[44:47], v[112:115], v[16:19], 0
    v_mfma_f32_16x16x32_bf16 v[44:47], v[116:119], v[20:23], v[44:47]
    v_mfma_f32_16x16x32_bf16 v[48:51], v[120:123], v[16:19], 0
    v_mfma_f32_16x16x32_bf16 v[48:51], v[124:127], v[20:23], v[48:51]
    s_nop 1
    v_add_f32_dpp v52, v37, v36 row_ror:12 row_mask:0xf bank_mask:0xf
    s_nop 0
    v_add_f32_dpp v53, v42, v41 row_ror:12 row_mask:0xf bank_mask:0xf
    s_nop 0
    v_add_f32_dpp v54, v47, v46 row_ror:12 row_mask:0xf bank_mask:0xf
    s_nop 0
    v_add_f32_dpp v55, v48, v51 row_ror:12 row_mask:0xf bank_mask:0xf
    v_add_f32_dpp v52, v38, v52 row_ror:8 row_mask:0xf bank_mask:0xf
    v_add_f32_dpp v53, v43, v53 row_ror:8 row_mask:0xf bank_mask:0xf
    v_add_f32_dpp v54, v44, v54 row_ror:8 row_mask:0xf bank_mask:0xf
    v_add_f32_dpp v55, v49, v55 row_ror:8 row_mask:0xf bank_mask:0xf
    v_add_f32_dpp v9, v39, v52 row_ror:4 row_mask:0xf bank_mask:0x1
    s_nop 1
    v_add_f32_dpp v9, v40, v53 row_ror:4 row_mask:0xf bank_mask:0x2
    s_nop 1
    v_add_f32_dpp v9, v45, v54 row_ror:4 row_mask:0xf bank_mask:0x4
    s_nop 1
    v_add_f32_dpp v9, v50, v55 row_ror:4 row_mask:0xf bank_mask:0x8
    v_cvt_pk_bf16_f32 v9, 0, v9
    v_mul_f32 v9, s18, v9
    v_cvt_pk_bf16_f32 v10, 0, v9
    v_max_f32 v7, v7, v10
    ds_write_b16_d16_hi v14, v10 offset:128
    s_xor_b32 s15, s16, 0x200000
    s_waitcnt vmcnt(4)
    buffer_load_dwordx4 v[72:75], v2, s[8:11], s15 offen offset:0 nt
    s_waitcnt vmcnt(4)
    buffer_load_dwordx4 v[76:79], v2, s[8:11], s15 offen offset:1024 nt
    v_mfma_f32_16x16x32_bf16 v[36:39], v[128:131], v[16:19], 0
    v_mfma_f32_16x16x32_bf16 v[36:39], v[132:135], v[20:23], v[36:39]
    v_mfma_f32_16x16x32_bf16 v[40:43], v[136:139], v[16:19], 0
    v_mfma_f32_16x16x32_bf16 v[40:43], v[140:143], v[20:23], v[40:43]
    v_mfma_f32_16x16x32_bf16 v[44:47], v[144:147], v[16:19], 0
    v_mfma_f32_16x16x32_bf16 v[44:47], v[148:151], v[20:23], v[44:47]
    v_mfma_f32_16x16x32_bf16 v[48:51], v[152:155], v[16:19], 0
    v_mfma_f32_16x16x32_bf16 v[48:51], v[156:159], v[20:23], v[48:51]
    s_nop 1
    v_add_f32_dpp v52, v37, v36 row_ror:12 row_mask:0xf bank_mask:0xf
    s_nop 0
    v_add_f32_dpp v53, v42, v41 row_ror:12 row_mask:0xf bank_mask:0xf
    s_nop 0
    v_add_f32_dpp v54, v47, v46 row_ror:12 row_mask:0xf bank_mask:0xf
    s_nop 0
    v_add_f32_dpp v55, v48, v51 row_ror:12 row_mask:0xf bank_mask:0xf
    v_add_f32_dpp v52, v38, v52 row_ror:8 row_mask:0xf bank_mask:0xf
    v_add_f32_dpp v53, v43, v53 row_ror:8 row_mask:0xf bank_mask:0xf
    v_add_f32_dpp v54, v44, v54 row_ror:8 row_mask:0xf bank_mask:0xf
    v_add_f32_dpp v55, v49, v55 row_ror:8 row_mask:0xf bank_mask:0xf
    v_add_f32_dpp v9, v39, v52 row_ror:4 row_mask:0xf bank_mask:0x1
    s_nop 1
    v_add_f32_dpp v9, v40, v53 row_ror:4 row_mask:0xf bank_mask:0x2
    s_nop 1
    v_add_f32_dpp v9, v45, v54 row_ror:4 row_mask:0xf bank_mask:0x4
    s_nop 1
    v_add_f32_dpp v9, v50, v55 row_ror:4 row_mask:0xf bank_mask:0x8
    v_cvt_pk_bf16_f32 v9, 0, v9
    v_mul_f32 v9, s18, v9
    v_cvt_pk_bf16_f32 v10, 0, v9
    v_max_f32 v7, v7, v10
    ds_write_b16_d16_hi v14, v10 offset:256
    s_xor_b32 s15, s16, 0x400000
    s_waitcnt vmcnt(4)
    buffer_load_dwordx4 v[80:83], v2, s[8:11], s15 offen offset:0 nt
    s_waitcnt vmcnt(4)
    buffer_load_dwordx4 v[84:87], v2, s[8:11], s15 offen offset:1024 nt
    v_mfma_f32_16x16x32_bf16 v[36:39], v[160:163], v[16:19], 0
    v_mfma_f32_16x16x32_bf16 v[36:39], v[164:167], v[20:23], v[36:39]
    v_mfma_f32_16x16x32_bf16 v[40:43], v[168:171], v[16:19], 0
    v_mfma_f32_16x16x32_bf16 v[40:43], v[172:175], v[20:23], v[40:43]
    v_mfma_f32_16x16x32_bf16 v[44:47], v[176:179], v[16:19], 0
    v_mfma_f32_16x16x32_bf16 v[44:47], v[180:183], v[20:23], v[44:47]
    v_mfma_f32_16x16x32_bf16 v[48:51], v[184:187], v[16:19], 0
    v_mfma_f32_16x16x32_bf16 v[48:51], v[188:191], v[20:23], v[48:51]
    s_nop 1
    v_add_f32_dpp v52, v37, v36 row_ror:12 row_mask:0xf bank_mask:0xf
    s_nop 0
    v_add_f32_dpp v53, v42, v41 row_ror:12 row_mask:0xf bank_mask:0xf
    s_nop 0
    v_add_f32_dpp v54, v47, v46 row_ror:12 row_mask:0xf bank_mask:0xf
    s_nop 0
    v_add_f32_dpp v55, v48, v51 row_ror:12 row_mask:0xf bank_mask:0xf
    v_add_f32_dpp v52, v38, v52 row_ror:8 row_mask:0xf bank_mask:0xf
    v_add_f32_dpp v53, v43, v53 row_ror:8 row_mask:0xf bank_mask:0xf
    v_add_f32_dpp v54, v44, v54 row_ror:8 row_mask:0xf bank_mask:0xf
    v_add_f32_dpp v55, v49, v55 row_ror:8 row_mask:0xf bank_mask:0xf
    v_add_f32_dpp v9, v39, v52 row_ror:4 row_mask:0xf bank_mask:0x1
    s_nop 1
    v_add_f32_dpp v9, v40, v53 row_ror:4 row_mask:0xf bank_mask:0x2
    s_nop 1
    v_add_f32_dpp v9, v45, v54 row_ror:4 row_mask:0xf bank_mask:0x4
    s_nop 1
    v_add_f32_dpp v9, v50, v55 row_ror:4 row_mask:0xf bank_mask:0x8
    v_cvt_pk_bf16_f32 v9, 0, v9
    v_mul_f32 v9, s18, v9
    v_cvt_pk_bf16_f32 v10, 0, v9
    v_max_f32 v7, v7, v10
    ds_write_b16_d16_hi v14, v10 offset:384
    s_xor_b32 s15, s16, 0x600000
    s_waitcnt vmcnt(4)
    buffer_load_dwordx4 v[88:91], v2, s[8:11], s15 offen offset:0 nt
    s_waitcnt vmcnt(4)
    buffer_load_dwordx4 v[92:95], v2, s[8:11], s15 offen offset:1024 nt
    s_add_u32 s14, s14, 1
    s_bfe_u32 s15, s14, 0x10000
    s_lshl_b32 s15, s15, 23
    s_xor_b32 s16, s30, s15
    s_bfe_u32 s15, s14, 0x40001
    s_lshl_b32 s15, s15, 17
    s_xor_b32 s16, s16, s15
    v_mfma_f32_16x16x32_bf16 v[36:39], v[192:195], v[16:19], 0
    v_mfma_f32_16x16x32_bf16 v[36:39], v[196:199], v[20:23], v[36:39]
    v_mfma_f32_16x16x32_bf16 v[40:43], v[200:203], v[16:19], 0
    v_mfma_f32_16x16x32_bf16 v[40:43], v[204:207], v[20:23], v[40:43]
    v_mfma_f32_16x16x32_bf16 v[44:47], v[208:211], v[16:19], 0
    v_mfma_f32_16x16x32_bf16 v[44:47], v[212:215], v[20:23], v[44:47]
    v_mfma_f32_16x16x32_bf16 v[48:51], v[216:219], v[16:19], 0
    v_mfma_f32_16x16x32_bf16 v[48:51], v[220:223], v[20:23], v[48:51]
    s_nop 1
    v_add_f32_dpp v52, v37, v36 row_ror:12 row_mask:0xf bank_mask:0xf
    s_nop 0
    v_add_f32_dpp v53, v42, v41 row_ror:12 row_mask:0xf bank_mask:0xf
    s_nop 0
    v_add_f32_dpp v54, v47, v46 row_ror:12 row_mask:0xf bank_mask:0xf
    s_nop 0
    v_add_f32_dpp v55, v48, v51 row_ror:12 row_mask:0xf bank_mask:0xf
    v_add_f32_dpp v52, v38, v52 row_ror:8 row_mask:0xf bank_mask:0xf
    v_add_f32_dpp v53, v43, v53 row_ror:8 row_mask:0xf bank_mask:0xf
    v_add_f32_dpp v54, v44, v54 row_ror:8 row_mask:0xf bank_mask:0xf
    v_add_f32_dpp v55, v49, v55 row_ror:8 row_mask:0xf bank_mask:0xf
    v_add_f32_dpp v9, v39, v52 row_ror:4 row_mask:0xf bank_mask:0x1
    s_nop 1
    v_add_f32_dpp v9, v40, v53 row_ror:4 row_mask:0xf bank_mask:0x2
    s_nop 1
    v_add_f32_dpp v9, v45, v54 row_ror:4 row_mask:0xf bank_mask:0x4
    s_nop 1
    v_add_f32_dpp v9, v50, v55 row_ror:4 row_mask:0xf bank_mask:0x8
    v_cvt_pk_bf16_f32 v9, 0, v9
    v_mul_f32 v9, s18, v9
    v_cvt_pk_bf16_f32 v10, 0, v9
    v_max_f32 v7, v7, v10
    ds_write_b16_d16_hi v14, v10 offset:512
    v_mfma_f32_16x16x32_bf16 v[36:39], v[224:227], v[16:19], 0
    v_mfma_f32_16x16x32_bf16 v[36:39], v[228:231], v[20:23], v[36:39]
    v_mfma_f32_16x16x32_bf16 v[40:43], v[232:235], v[16:19], 0
    v_mfma_f32_16x16x32_bf16 v[40:43], v[236:239], v[20:23], v[40:43]
    v_mfma_f32_16x16x32_bf16 v[44:47], v[240:243], v[16:19], 0
    v_mfma_f32_16x16x32_bf16 v[44:47], v[244:247], v[20:23], v[44:47]
    v_mfma_f32_16x16x32_bf16 v[48:51], v[248:251], v[16:19], 0
    v_mfma_f32_16x16x32_bf16 v[48:51], v[252:255], v[20:23], v[48:51]
    s_nop 1
    v_add_f32_dpp v52, v37, v36 row_ror:12 row_mask:0xf bank_mask:0xf
    s_nop 0
    v_add_f32_dpp v53, v42, v41 row_ror:12 row_mask:0xf bank_mask:0xf
    s_nop 0
    v_add_f32_dpp v54, v47, v46 row_ror:12 row_mask:0xf bank_mask:0xf
    s_nop 0
    v_add_f32_dpp v55, v48, v51 row_ror:12 row_mask:0xf bank_mask:0xf
    v_add_f32_dpp v52, v38, v52 row_ror:8 row_mask:0xf bank_mask:0xf
    v_add_f32_dpp v53, v43, v53 row_ror:8 row_mask:0xf bank_mask:0xf
    v_add_f32_dpp v54, v44, v54 row_ror:8 row_mask:0xf bank_mask:0xf
    v_add_f32_dpp v55, v49, v55 row_ror:8 row_mask:0xf bank_mask:0xf
    v_add_f32_dpp v9, v39, v52 row_ror:4 row_mask:0xf bank_mask:0x1
    s_nop 1
    v_add_f32_dpp v9, v40, v53 row_ror:4 row_mask:0xf bank_mask:0x2
    s_nop 1
    v_add_f32_dpp v9, v45, v54 row_ror:4 row_mask:0xf bank_mask:0x4
    s_nop 1
    v_add_f32_dpp v9, v50, v55 row_ror:4 row_mask:0xf bank_mask:0x8
    v_cvt_pk_bf16_f32 v9, 0, v9
    v_mul_f32 v9, s18, v9
    v_cvt_pk_bf16_f32 v10, 0, v9
    v_max_f32 v7, v7, v10
    ds_write_b16_d16_hi v14, v10 offset:640
    ds_read_b128 v[128:131], v58 offset:0
    ds_read_b128 v[132:135], v58 offset:1024
    ds_read_b128 v[136:139], v58 offset:2048
    ds_read_b128 v[140:143], v58 offset:3072
    ds_read_b128 v[144:147], v58 offset:4096
    ds_read_b128 v[148:151], v58 offset:5120
    ds_read_b128 v[152:155], v58 offset:6144
    ds_read_b128 v[156:159], v58 offset:7168
    s_waitcnt vmcnt(4)
    buffer_load_dwordx4 v[96:99], v2, s[8:11], s16 offen offset:0 nt
    s_waitcnt vmcnt(4)
    buffer_load_dwordx4 v[100:103], v2, s[8:11], s16 offen offset:1024 nt
    s_waitcnt lgkmcnt(0)
    v_mfma_f32_16x16x32_bf16 v[36:39], v[128:131], v[16:19], 0
    v_mfma_f32_16x16x32_bf16 v[36:39], v[132:135], v[20:23], v[36:39]
    v_mfma_f32_16x16x32_bf16 v[40:43], v[136:139], v[16:19], 0
    v_mfma_f32_16x16x32_bf16 v[40:43], v[140:143], v[20:23], v[40:43]
    v_mfma_f32_16x16x32_bf16 v[44:47], v[144:147], v[16:19], 0
    v_mfma_f32_16x16x32_bf16 v[44:47], v[148:151], v[20:23], v[44:47]
    v_mfma_f32_16x16x32_bf16 v[48:51], v[152:155], v[16:19], 0
    v_mfma_f32_16x16x32_bf16 v[48:51], v[156:159], v[20:23], v[48:51]
    s_nop 1
    v_add_f32_dpp v52, v37, v36 row_ror:12 row_mask:0xf bank_mask:0xf
    s_nop 0
    v_add_f32_dpp v53, v42, v41 row_ror:12 row_mask:0xf bank_mask:0xf
    s_nop 0
    v_add_f32_dpp v54, v47, v46 row_ror:12 row_mask:0xf bank_mask:0xf
    s_nop 0
    v_add_f32_dpp v55, v48, v51 row_ror:12 row_mask:0xf bank_mask:0xf
    v_add_f32_dpp v52, v38, v52 row_ror:8 row_mask:0xf bank_mask:0xf
    v_add_f32_dpp v53, v43, v53 row_ror:8 row_mask:0xf bank_mask:0xf
    v_add_f32_dpp v54, v44, v54 row_ror:8 row_mask:0xf bank_mask:0xf
    v_add_f32_dpp v55, v49, v55 row_ror:8 row_mask:0xf bank_mask:0xf
    v_add_f32_dpp v9, v39, v52 row_ror:4 row_mask:0xf bank_mask:0x1
    s_nop 1
    v_add_f32_dpp v9, v40, v53 row_ror:4 row_mask:0xf bank_mask:0x2
    s_nop 1
    v_add_f32_dpp v9, v45, v54 row_ror:4 row_mask:0xf bank_mask:0x4
    s_nop 1
    v_add_f32_dpp v9, v50, v55 row_ror:4 row_mask:0xf bank_mask:0x8
    v_cvt_pk_bf16_f32 v9, 0, v9
    v_mul_f32 v9, s18, v9
    v_cvt_pk_bf16_f32 v10, 0, v9
    v_max_f32 v7, v7, v10
    ds_write_b16_d16_hi v14, v10 offset:768
    ds_read_b128 v[160:163], v58 offset:8192
    ds_read_b128 v[164:167], v58 offset:9216
    ds_read_b128 v[168:171], v58 offset:10240
    ds_read_b128 v[172:175], v58 offset:11264
    ds_read_b128 v[176:179], v58 offset:12288
    ds_read_b128 v[180:183], v58 offset:13312
    ds_read_b128 v[184:187], v58 offset:14336
    ds_read_b128 v[188:191], v58 offset:15360
    s_xor_b32 s15, s16, 0x200000
    s_waitcnt vmcnt(4)
    buffer_load_dwordx4 v[104:107], v2, s[8:11], s15 offen offset:0 nt
    s_waitcnt vmcnt(4)
    buffer_load_dwordx4 v[108:111], v2, s[8:11], s15 offen offset:1024 nt
    s_waitcnt lgkmcnt(0)
    v_mfma_f32_16x16x32_bf16 v[36:39], v[160:163], v[16:19], 0
    v_mfma_f32_16x16x32_bf16 v[36:39], v[164:167], v[20:23], v[36:39]
    v_mfma_f32_16x16x32_bf16 v[40:43], v[168:171], v[16:19], 0
    v_mfma_f32_16x16x32_bf16 v[40:43], v[172:175], v[20:23], v[40:43]
    v_mfma_f32_16x16x32_bf16 v[44:47], v[176:179], v[16:19], 0
    v_mfma_f32_16x16x32_bf16 v[44:47], v[180:183], v[20:23], v[44:47]
    v_mfma_f32_16x16x32_bf16 v[48:51], v[184:187], v[16:19], 0
    v_mfma_f32_16x16x32_bf16 v[48:51], v[188:191], v[20:23], v[48:51]
    s_nop 1
    v_add_f32_dpp v52, v37, v36 row_ror:12 row_mask:0xf bank_mask:0xf
    s_nop 0
    v_add_f32_dpp v53, v42, v41 row_ror:12 row_mask:0xf bank_mask:0xf
    s_nop 0
    v_add_f32_dpp v54, v47, v46 row_ror:12 row_mask:0xf bank_mask:0xf
    s_nop 0
    v_add_f32_dpp v55, v48, v51 row_ror:12 row_mask:0xf bank_mask:0xf
    v_add_f32_dpp v52, v38, v52 row_ror:8 row_mask:0xf bank_mask:0xf
    v_add_f32_dpp v53, v43, v53 row_ror:8 row_mask:0xf bank_mask:0xf
    v_add_f32_dpp v54, v44, v54 row_ror:8 row_mask:0xf bank_mask:0xf
    v_add_f32_dpp v55, v49, v55 row_ror:8 row_mask:0xf bank_mask:0xf
    v_add_f32_dpp v9, v39, v52 row_ror:4 row_mask:0xf bank_mask:0x1
    s_nop 1
    v_add_f32_dpp v9, v40, v53 row_ror:4 row_mask:0xf bank_mask:0x2
    s_nop 1
    v_add_f32_dpp v9, v45, v54 row_ror:4 row_mask:0xf bank_mask:0x4
    s_nop 1
    v_add_f32_dpp v9, v50, v55 row_ror:4 row_mask:0xf bank_mask:0x8
    v_cvt_pk_bf16_f32 v9, 0, v9
    v_mul_f32 v9, s18, v9
    v_cvt_pk_bf16_f32 v10, 0, v9
    v_max_f32 v7, v7, v10
    ds_write_b16_d16_hi v14, v10 offset:896
    ds_read_b128 v[192:195], v58 offset:16384
    ds_read_b128 v[196:199], v58 offset:17408
    ds_read_b128 v[200:203], v58 offset:18432
    ds_read_b128 v[204:207], v58 offset:19456
    ds_read_b128 v[208:211], v58 offset:20480
    ds_read_b128 v[212:215], v58 offset:21504
    ds_read_b128 v[216:219], v58 offset:22528
    ds_read_b128 v[220:223], v58 offset:23552
    s_xor_b32 s15, s16, 0x400000
    s_waitcnt vmcnt(4)
    buffer_load_dwordx4 v[112:115], v2, s[8:11], s15 offen offset:0 nt
    s_waitcnt lgkmcnt(0)
    v_mfma_f32_16x16x32_bf16 v[36:39], v[192:195], v[16:19], 0
    v_mfma_f32_16x16x32_bf16 v[36:39], v[196:199], v[20:23], v[36:39]
    v_mfma_f32_16x16x32_bf16 v[40:43], v[200:203], v[16:19], 0
    v_mfma_f32_16x16x32_bf16 v[40:43], v[204:207], v[20:23], v[40:43]
    v_mfma_f32_16x16x32_bf16 v[44:47], v[208:211], v[16:19], 0
    v_mfma_f32_16x16x32_bf16 v[44:47], v[212:215], v[20:23], v[44:47]
    v_mfma_f32_16x16x32_bf16 v[48:51], v[216:219], v[16:19], 0
    v_mfma_f32_16x16x32_bf16 v[48:51], v[220:223], v[20:23], v[48:51]
    s_nop 1
    v_add_f32_dpp v52, v37, v36 row_ror:12 row_mask:0xf bank_mask:0xf
    s_nop 0
    v_add_f32_dpp v53, v42, v41 row_ror:12 row_mask:0xf bank_mask:0xf
    s_nop 0
    v_add_f32_dpp v54, v47, v46 row_ror:12 row_mask:0xf bank_mask:0xf
    s_nop 0
    v_add_f32_dpp v55, v48, v51 row_ror:12 row_mask:0xf bank_mask:0xf
    v_add_f32_dpp v52, v38, v52 row_ror:8 row_mask:0xf bank_mask:0xf
    v_add_f32_dpp v53, v43, v53 row_ror:8 row_mask:0xf bank_mask:0xf
    v_add_f32_dpp v54, v44, v54 row_ror:8 row_mask:0xf bank_mask:0xf
    v_add_f32_dpp v55, v49, v55 row_ror:8 row_mask:0xf bank_mask:0xf
    v_add_f32_dpp v9, v39, v52 row_ror:4 row_mask:0xf bank_mask:0x1
    s_nop 1
    v_add_f32_dpp v9, v40, v53 row_ror:4 row_mask:0xf bank_mask:0x2
    s_nop 1
    v_add_f32_dpp v9, v45, v54 row_ror:4 row_mask:0xf bank_mask:0x4
    s_nop 1
    v_add_f32_dpp v9, v50, v55 row_ror:4 row_mask:0xf bank_mask:0x8
    v_cvt_pk_bf16_f32 v9, 0, v9
    v_mul_f32 v9, s18, v9
    v_cvt_pk_bf16_f32 v10, 0, v9
    v_max_f32 v7, v7, v10
    ds_write_b16_d16_hi v14, v10 offset:1024
    ds_read_b128 v[224:227], v58 offset:24576
    ds_read_b128 v[228:231], v58 offset:25600
    ds_read_b128 v[232:235], v58 offset:26624
    ds_read_b128 v[236:239], v58 offset:27648
    ds_read_b128 v[240:243], v58 offset:28672
    ds_read_b128 v[244:247], v58 offset:29696
    ds_read_b128 v[248:251], v58 offset:30720
    ds_read_b128 v[252:255], v58 offset:31744
    s_waitcnt vmcnt(4)
    buffer_load_dwordx4 v[116:119], v2, s[8:11], s15 offen offset:1024 nt
    s_xor_b32 s15, s16, 0x600000
    s_waitcnt vmcnt(4)
    buffer_load_dwordx4 v[120:123], v2, s[8:11], s15 offen offset:0 nt
    s_waitcnt lgkmcnt(0)
    v_mfma_f32_16x16x32_bf16 v[36:39], v[224:227], v[16:19], 0
    v_mfma_f32_16x16x32_bf16 v[36:39], v[228:231], v[20:23], v[36:39]
    v_mfma_f32_16x16x32_bf16 v[40:43], v[232:235], v[16:19], 0
    v_mfma_f32_16x16x32_bf16 v[40:43], v[236:239], v[20:23], v[40:43]
    v_mfma_f32_16x16x32_bf16 v[44:47], v[240:243], v[16:19], 0
    v_mfma_f32_16x16x32_bf16 v[44:47], v[244:247], v[20:23], v[44:47]
    v_mfma_f32_16x16x32_bf16 v[48:51], v[248:251], v[16:19], 0
    v_mfma_f32_16x16x32_bf16 v[48:51], v[252:255], v[20:23], v[48:51]
    s_nop 1
    v_add_f32_dpp v52, v37, v36 row_ror:12 row_mask:0xf bank_mask:0xf
    s_nop 0
    v_add_f32_dpp v53, v42, v41 row_ror:12 row_mask:0xf bank_mask:0xf
    s_nop 0
    v_add_f32_dpp v54, v47, v46 row_ror:12 row_mask:0xf bank_mask:0xf
    s_nop 0
    v_add_f32_dpp v55, v48, v51 row_ror:12 row_mask:0xf bank_mask:0xf
    v_add_f32_dpp v52, v38, v52 row_ror:8 row_mask:0xf bank_mask:0xf
    v_add_f32_dpp v53, v43, v53 row_ror:8 row_mask:0xf bank_mask:0xf
    v_add_f32_dpp v54, v44, v54 row_ror:8 row_mask:0xf bank_mask:0xf
    v_add_f32_dpp v55, v49, v55 row_ror:8 row_mask:0xf bank_mask:0xf
    v_add_f32_dpp v9, v39, v52 row_ror:4 row_mask:0xf bank_mask:0x1
    s_nop 1
    v_add_f32_dpp v9, v40, v53 row_ror:4 row_mask:0xf bank_mask:0x2
    s_nop 1
    v_add_f32_dpp v9, v45, v54 row_ror:4 row_mask:0xf bank_mask:0x4
    s_nop 1
    v_add_f32_dpp v9, v50, v55 row_ror:4 row_mask:0xf bank_mask:0x8
    v_cvt_pk_bf16_f32 v9, 0, v9
    v_mul_f32 v9, s18, v9
    v_cvt_pk_bf16_f32 v10, 0, v9
    v_max_f32 v7, v7, v10
    ds_write_b16_d16_hi v14, v10 offset:1152
    s_waitcnt vmcnt(4)
    buffer_load_dwordx4 v[124:127], v2, s[8:11], s15 offen offset:1024 nt
    s_add_u32 s14, s14, 1
    s_bfe_u32 s15, s14, 0x10000
    s_lshl_b32 s15, s15, 23
    s_xor_b32 s16, s30, s15
    s_bfe_u32 s15, s14, 0x40001
    s_lshl_b32 s15, s15, 17
    s_xor_b32 s16, s16, s15
    v_add_u32 v14, 1280, v14
    v_mov_b32 v59, 1
    v_mov_b32 v60, 0
    v_mov_b32 v61, 0
    s_lshl_b32 s20, s3, 2
    v_mov_b32 v62, s20
    v_mov_b32 v63, 0
    s_mov_b32 s33, 4
    s_mov_b32 s31, -12
L_kloop:
    s_cmp_lg_u32 s17, 1
    s_cbranch_scc1 L_kbody
    s_mov_b32 s8, s12
    s_mov_b32 s9, s13
    v_mov_b32 v2, v4
L_kbody:
    v_mfma_f32_16x16x32_bf16 v[36:39], v[64:67], v[16:19], 0
    s_waitcnt lgkmcnt(1)
    v_cmp_lt_i32 vcc, s33, v63
    v_cmp_gt_i32 s[22:23], s31, v63
    ds_read_b32 v63, v62 offset:32
    s_waitcnt vmcnt(5)
    s_cbranch_vccnz L_w_1
    s_bitcmp1_b32 s22, 0
    s_waitcnt vmcnt(4)
    s_cbranch_scc0 L_w_1
    s_waitcnt vmcnt(3)
L_w_1:
    buffer_load_dwordx4 v[64:67], v2, s[8:11], s16 offen offset:0 nt
    v_mfma_f32_16x16x32_bf16 v[36:39], v[68:71], v[20:23], v[36:39]
    s_waitcnt vmcnt(5)
    s_cbranch_vccnz L_w_2
    s_bitcmp1_b32 s22, 0
    s_waitcnt vmcnt(4)
    s_cbranch_scc0 L_w_2
    s_waitcnt vmcnt(3)
L_w_2:
    buffer_load_dwordx4 v[68:71], v2, s[8:11], s16 offen offset:1024 nt
    v_add_u32 v61, 1, v61
    ds_write_b32 v62, v61 offset:240
    v_mfma_f32_16x16x32_bf16 v[40:43], v[72:75], v[16:19], 0
    s_xor_b32 s15, s16, 0x200000
    s_waitcnt lgkmcnt(1)
    v_cmp_lt_i32 vcc, s33, v63
    v_cmp_gt_i32 s[22:23], s31, v63
    ds_read_b32 v63, v62 offset:32
    s_waitcnt vmcnt(5)
    s_cbranch_vccnz L_w_3
    s_bitcmp1_b32 s22, 0
    s_waitcnt vmcnt(4)
    s_cbranch_scc0 L_w_3
    s_waitcnt vmcnt(3)
L_w_3:
    buffer_load_dwordx4 v[72:75], v2, s[8:11], s15 offen offset:0 nt
    v_mfma_f32_16x16x32_bf16 v[40:43], v[76:79], v[20:23], v[40:43]
    s_waitcnt vmcnt(5)
    s_cbranch_vccnz L_w_4
    s_bitcmp1_b32 s22, 0
    s_waitcnt vmcnt(4)
    s_cbranch_scc0 L_w_4
    s_waitcnt vmcnt(3)
L_w_4:
    buffer_load_dwordx4 v[76:79], v2, s[8:11], s15 offen offset:1024 nt
    v_add_u32 v61, 1, v61
    ds_write_b32 v62, v61 offset:240
    v_mfma_f32_16x16x32_bf16 v[44:47], v[80:83], v[16:19], 0
    s_xor_b32 s15, s16, 0x400000
    s_waitcnt lgkmcnt(1)
    v_cmp_lt_i32 vcc, s33, v63
    v_cmp_gt_i32 s[22:23], s31, v63
    ds_read_b32 v63, v62 offset:32
    s_waitcnt vmcnt(5)
    s_cbranch_vccnz L_w_5
    s_bitcmp1_b32 s22, 0
    s_waitcnt vmcnt(4)
    s_cbranch_scc0 L_w_5
    s_waitcnt vmcnt(3)
L_w_5:
    buffer_load_dwordx4 v[80:83], v2, s[8:11], s15 offen offset:0 nt
    v_mfma_f32_16x16x32_bf16 v[44:47], v[84:87], v[20:23], v[44:47]
    s_waitcnt vmcnt(5)
    s_cbranch_vccnz L_w_6
    s_bitcmp1_b32 s22, 0
    s_waitcnt vmcnt(4)
    s_cbranch_scc0 L_w_6
    s_waitcnt vmcnt(3)
L_w_6:
    buffer_load_dwordx4 v[84:87], v2, s[8:11], s15 offen offset:1024 nt
    v_add_u32 v61, 1, v61
    ds_write_b32 v62, v61 offset:240
    v_mfma_f32_16x16x32_bf16 v[48:51], v[88:91], v[16:19], 0
    s_xor_b32 s15, s16, 0x600000
    s_waitcnt lgkmcnt(1)
    v_cmp_lt_i32 vcc, s33, v63
    v_cmp_gt_i32 s[22:23], s31, v63
    ds_read_b32 v63, v62 offset:32
    s_waitcnt vmcnt(5)
    s_cbranch_vccnz L_w_7
    s_bitcmp1_b32 s22, 0
    s_waitcnt vmcnt(4)
    s_cbranch_scc0 L_w_7
    s_waitcnt vmcnt(3)
L_w_7:
    buffer_load_dwordx4 v[88:91], v2, s[8:11], s15 offen offset:0 nt
    v_mfma_f32_16x16x32_bf16 v[48:51], v[92:95], v[20:23], v[48:51]
    s_waitcnt vmcnt(5)
    s_cbranch_vccnz L_w_8
    s_bitcmp1_b32 s22, 0
    s_waitcnt vmcnt(4)
    s_cbranch_scc0 L_w_8
    s_waitcnt vmcnt(3)
L_w_8:
    buffer_load_dwordx4 v[92:95], v2, s[8:11], s15 offen offset:1024 nt
    v_add_u32 v61, 1, v61
    ds_write_b32 v62, v61 offset:240
    s_add_u32 s14, s14, 1
    s_bfe_u32 s15, s14, 0x10000
    s_lshl_b32 s15, s15, 23
    s_xor_b32 s16, s30, s15
    s_bfe_u32 s15, s14, 0x40001
    s_lshl_b32 s15, s15, 17
    s_xor_b32 s16, s16, s15
    v_add_f32_dpp v52, v37, v36 row_ror:12 row_mask:0xf bank_mask:0xf
    v_add_f32_dpp v53, v42, v41 row_ror:12 row_mask:0xf bank_mask:0xf
    v_add_f32_dpp v54, v47, v46 row_ror:12 row_mask:0xf bank_mask:0xf
    v_add_f32_dpp v55, v48, v51 row_ror:12 row_mask:0xf bank_mask:0xf
    v_add_f32_dpp v52, v38, v52 row_ror:8 row_mask:0xf bank_mask:0xf
    v_add_f32_dpp v53, v43, v53 row_ror:8 row_mask:0xf bank_mask:0xf
    v_add_f32_dpp v54, v44, v54 row_ror:8 row_mask:0xf bank_mask:0xf
    v_add_f32_dpp v55, v49, v55 row_ror:8 row_mask:0xf bank_mask:0xf
    v_add_f32_dpp v9, v39, v52 row_ror:4 row_mask:0xf bank_mask:0x1
    s_nop 1
    v_add_f32_dpp v9, v40, v53 row_ror:4 row_mask:0xf bank_mask:0x2
    s_nop 1
    v_add_f32_dpp v9, v45, v54 row_ror:4 row_mask:0xf bank_mask:0x4
    s_nop 1
    v_add_f32_dpp v9, v50, v55 row_ror:4 row_mask:0xf bank_mask:0x8
    v_cvt_pk_bf16_f32 v9, 0, v9
    v_mul_f32 v9, s18, v9
    v_cvt_pk_bf16_f32 v10, 0, v9
    v_max_f32 v7, v7, v10
    ds_write_b16_d16_hi v14, v10 offset:0
    v_mfma_f32_16x16x32_bf16 v[36:39], v[96:99], v[16:19], 0
    s_waitcnt lgkmcnt(1)
    v_cmp_lt_i32 vcc, s33, v63
    v_cmp_gt_i32 s[22:23], s31, v63
    ds_read_b32 v63, v62 offset:32
    s_waitcnt vmcnt(5)
    s_cbranch_vccnz L_w_9
    s_bitcmp1_b32 s22, 0
    s_waitcnt vmcnt(4)
    s_cbranch_scc0 L_w_9
    s_waitcnt vmcnt(3)
L_w_9:
    buffer_load_dwordx4 v[96:99], v2, s[8:11], s16 offen offset:0 nt
    v_mfma_f32_16x16x32_bf16 v[36:39], v[100:103], v[20:23], v[36:39]
    s_waitcnt vmcnt(5)
    s_cbranch_vccnz L_w_10
    s_bitcmp1_b32 s22, 0
    s_waitcnt vmcnt(4)
    s_cbranch_scc0 L_w_10
    s_waitcnt vmcnt(3)
L_w_10:
    buffer_load_dwordx4 v[100:103], v2, s[8:11], s16 offen offset:1024 nt
    v_add_u32 v61, 1, v61
    ds_write_b32 v62, v61 offset:240
    v_mfma_f32_16x16x32_bf16 v[40:43], v[104:107], v[16:19], 0
    s_xor_b32 s15, s16, 0x200000
    s_waitcnt lgkmcnt(1)
    v_cmp_lt_i32 vcc, s33, v63
    v_cmp_gt_i32 s[22:23], s31, v63
    ds_read_b32 v63, v62 offset:32
    s_waitcnt vmcnt(5)
    s_cbranch_vccnz L_w_11
    s_bitcmp1_b32 s22, 0
    s_waitcnt vmcnt(4)
    s_cbranch_scc0 L_w_11
    s_waitcnt vmcnt(3)
L_w_11:
    buffer_load_dwordx4 v[104:107], v2, s[8:11], s15 offen offset:0 nt
    v_mfma_f32_16x16x32_bf16 v[40:43], v[108:111], v[20:23], v[40:43]
    s_waitcnt vmcnt(5)
    s_cbranch_vccnz L_w_12
    s_bitcmp1_b32 s22, 0
    s_waitcnt vmcnt(4)
    s_cbranch_scc0 L_w_12
    s_waitcnt vmcnt(3)
L_w_12:
    buffer_load_dwordx4 v[108:111], v2, s[8:11], s15 offen offset:1024 nt
    v_add_u32 v61, 1, v61
    ds_write_b32 v62, v61 offset:240
    v_mfma_f32_16x16x32_bf16 v[44:47], v[112:115], v[16:19], 0
    s_xor_b32 s15, s16, 0x400000
    s_waitcnt lgkmcnt(1)
    v_cmp_lt_i32 vcc, s33, v63
    v_cmp_gt_i32 s[22:23], s31, v63
    ds_read_b32 v63, v62 offset:32
    s_waitcnt vmcnt(5)
    s_cbranch_vccnz L_w_13
    s_bitcmp1_b32 s22, 0
    s_waitcnt vmcnt(4)
    s_cbranch_scc0 L_w_13
    s_waitcnt vmcnt(3)
L_w_13:
    buffer_load_dwordx4 v[112:115], v2, s[8:11], s15 offen offset:0 nt
    v_mfma_f32_16x16x32_bf16 v[44:47], v[116:119], v[20:23], v[44:47]
    s_waitcnt vmcnt(5)
    s_cbranch_vccnz L_w_14
    s_bitcmp1_b32 s22, 0
    s_waitcnt vmcnt(4)
    s_cbranch_scc0 L_w_14
    s_waitcnt vmcnt(3)
L_w_14:
    buffer_load_dwordx4 v[116:119], v2, s[8:11], s15 offen offset:1024 nt
    v_add_u32 v61, 1, v61
    ds_write_b32 v62, v61 offset:240
    v_mfma_f32_16x16x32_bf16 v[48:51], v[120:123], v[16:19], 0
    s_xor_b32 s15, s16, 0x600000
    s_waitcnt lgkmcnt(1)
    v_cmp_lt_i32 vcc, s33, v63
    v_cmp_gt_i32 s[22:23], s31, v63
    ds_read_b32 v63, v62 offset:32
    s_waitcnt vmcnt(5)
    s_cbranch_vccnz L_w_15
    s_bitcmp1_b32 s22, 0
    s_waitcnt vmcnt(4)
    s_cbranch_scc0 L_w_15
    s_waitcnt vmcnt(3)
L_w_15:
    buffer_load_dwordx4 v[120:123], v2, s[8:11], s15 offen offset:0 nt
    v_mfma_f32_16x16x32_bf16 v[48:51], v[124:127], v[20:23], v[48:51]
    s_waitcnt vmcnt(5)
    s_cbranch_vccnz L_w_16
    s_bitcmp1_b32 s22, 0
    s_waitcnt vmcnt(4)
    s_cbranch_scc0 L_w_16
    s_waitcnt vmcnt(3)
L_w_16:
    buffer_load_dwordx4 v[124:127], v2, s[8:11], s15 offen offset:1024 nt
    v_add_u32 v61, 1, v61
    ds_write_b32 v62, v61 offset:240
    s_add_u32 s14, s14, 1
    s_bfe_u32 s15, s14, 0x10000
    s_lshl_b32 s15, s15, 23
    s_xor_b32 s16, s30, s15
    s_bfe_u32 s15, s14, 0x40001
    s_lshl_b32 s15, s15, 17
    s_xor_b32 s16, s16, s15
    v_add_f32_dpp v52, v37, v36 row_ror:12 row_mask:0xf bank_mask:0xf
    v_add_f32_dpp v53, v42, v41 row_ror:12 row_mask:0xf bank_mask:0xf
    v_add_f32_dpp v54, v47, v46 row_ror:12 row_mask:0xf bank_mask:0xf
    v_add_f32_dpp v55, v48, v51 row_ror:12 row_mask:0xf bank_mask:0xf
    v_add_f32_dpp v52, v38, v52 row_ror:8 row_mask:0xf bank_mask:0xf
    v_add_f32_dpp v53, v43, v53 row_ror:8 row_mask:0xf bank_mask:0xf
    v_add_f32_dpp v54, v44, v54 row_ror:8 row_mask:0xf bank_mask:0xf
    v_add_f32_dpp v55, v49, v55 row_ror:8 row_mask:0xf bank_mask:0xf
    v_add_f32_dpp v9, v39, v52 row_ror:4 row_mask:0xf bank_mask:0x1
    s_nop 1
    v_add_f32_dpp v9, v40, v53 row_ror:4 row_mask:0xf bank_mask:0x2
    s_nop 1
    v_add_f32_dpp v9, v45, v54 row_ror:4 row_mask:0xf bank_mask:0x4
    s_nop 1
    v_add_f32_dpp v9, v50, v55 row_ror:4 row_mask:0xf bank_mask:0x8
    v_cvt_pk_bf16_f32 v9, 0, v9
    v_mul_f32 v9, s18, v9
    v_cvt_pk_bf16_f32 v10, 0, v9
    v_max_f32 v7, v7, v10
    ds_write_b16_d16_hi v14, v10 offset:128
    v_add_u32 v14, 256, v14
    s_sub_u32 s17, s17, 1
    s_cmp_lg_u32 s17, 0
    s_cbranch_scc1 L_kloop
L_vphase:
    v_subrev_u32 v14, 0x1000, v14
    ds_read_u16_d16_hi v56, v14
    ds_read_u16_d16_hi v57, v14 offset:128
    v_max_f32_dpp v7, v7, v7 quad_perm:[2,3,0,1] row_mask:0xf bank_mask:0xf
    s_nop 1
    v_max_f32_dpp v7, v7, v7 row_ror:4 row_mask:0xf bank_mask:0xf
    s_nop 1
    v_max_f32_dpp v7, v7, v7 row_ror:8 row_mask:0xf bank_mask:0xf
    v_mov_b32 v1, v7
    s_nop 1
    v_permlane16_swap_b32 v7, v1
    v_max_f32 v7, v7, v1
    v_mov_b32 v1, v7
    s_nop 1
    v_permlane32_swap_b32 v7, v1
    v_max_f32 v7, v7, v1
    s_lshl_b32 s20, s3, 3
    v_lshl_add_u32 v1, v0, 2, s20
    s_mov_b64 exec, 3
    ds_write_b32 v1, v7 offset:10240
    s_mov_b64 exec, 1
    ds_add_u32 v60, v59 offset:16
    s_mov_b64 exec, -1
    s_mov_b32 s17, 15
L_vloop:
    s_waitcnt lgkmcnt(1)
    v_sub_f32 v10, v56, v7
    v_mul_f32 v10, s19, v10
    v_exp_f32 v10, v10
    ds_read_u16_d16_hi v56, v14 offset:256
    v_cvt_pk_bf16_f32 v10, v10, v10
    s_nop 1
    v_and_b32_dpp v12, v10, v6 quad_perm:[0,0,1,1] row_mask:0xf bank_mask:0xf
    v_and_b32_dpp v13, v10, v6 quad_perm:[2,2,3,3] row_mask:0xf bank_mask:0xf
    s_nop 0
    v_mov_b32_dpp v28, v12 quad_perm:[0,1,2,3] row_mask:0xf bank_mask:0x1
    v_mov_b32_dpp v29, v12 row_ror:4 row_mask:0xf bank_mask:0x2
    v_mov_b32_dpp v30, v12 row_ror:8 row_mask:0xf bank_mask:0x4
    v_mov_b32_dpp v31, v12 row_ror:12 row_mask:0xf bank_mask:0x8
    v_mov_b32_dpp v32, v13 quad_perm:[0,1,2,3] row_mask:0xf bank_mask:0x1
    v_mov_b32_dpp v33, v13 row_ror:4 row_mask:0xf bank_mask:0x2
    v_mov_b32_dpp v34, v13 row_ror:8 row_mask:0xf bank_mask:0x4
    v_mov_b32_dpp v35, v13 row_ror:12 row_mask:0xf bank_mask:0x8
    v_mfma_f32_16x16x32_bf16 v[24:27], v[28:31], v[64:67], v[24:27]
    s_waitcnt lgkmcnt(1)
    v_cmp_lt_i32 vcc, s33, v63
    v_cmp_gt_i32 s[22:23], s31, v63
    ds_read_b32 v63, v62 offset:32
    s_waitcnt vmcnt(5)
    s_cbranch_vccnz L_w_17
    s_bitcmp1_b32 s22, 0
    s_waitcnt vmcnt(4)
    s_cbranch_scc0 L_w_17
    s_waitcnt vmcnt(3)
L_w_17:
    buffer_load_dwordx4 v[64:67], v2, s[8:11], s16 offen offset:0 nt
    v_mov_b32_dpp v28, v12 row_ror:12 row_mask:0xf bank_mask:0x1
    v_mov_b32_dpp v29, v12 quad_perm:[0,1,2,3] row_mask:0xf bank_mask:0x2
    v_mov_b32_dpp v30, v12 row_ror:4 row_mask:0xf bank_mask:0x4
    v_mov_b32_dpp v31, v12 row_ror:8 row_mask:0xf bank_mask:0x8
    v_mfma_f32_16x16x32_bf16 v[24:27], v[32:35], v[68:71], v[24:27]
    s_waitcnt vmcnt(5)
    s_cbranch_vccnz L_w_18
    s_bitcmp1_b32 s22, 0
    s_waitcnt vmcnt(4)
    s_cbranch_scc0 L_w_18
    s_waitcnt vmcnt(3)
L_w_18:
    buffer_load_dwordx4 v[68:71], v2, s[8:11], s16 offen offset:1024 nt
    v_add_u32 v61, 1, v61
    ds_write_b32 v62, v61 offset:240
    v_mov_b32_dpp v32, v13 row_ror:12 row_mask:0xf bank_mask:0x1
    v_mov_b32_dpp v33, v13 quad_perm:[0,1,2,3] row_mask:0xf bank_mask:0x2
    v_mov_b32_dpp v34, v13 row_ror:4 row_mask:0xf bank_mask:0x4
    v_mov_b32_dpp v35, v13 row_ror:8 row_mask:0xf bank_mask:0x8
    v_mfma_f32_16x16x32_bf16 v[24:27], v[28:31], v[72:75], v[24:27]
    s_xor_b32 s15, s16, 0x200000
    s_waitcnt lgkmcnt(1)
    v_cmp_lt_i32 vcc, s33, v63
    v_cmp_gt_i32 s[22:23], s31, v63
    ds_read_b32 v63, v62 offset:32
    s_waitcnt vmcnt(5)
    s_cbranch_vccnz L_w_19
    s_bitcmp1_b32 s22, 0
    s_waitcnt vmcnt(4)
    s_cbranch_scc0 L_w_19
    s_waitcnt vmcnt(3)
L_w_19:
    buffer_load_dwordx4 v[72:75], v2, s[8:11], s15 offen offset:0 nt
    v_mov_b32_dpp v28, v12 row_ror:8 row_mask:0xf bank_mask:0x1
    v_mov_b32_dpp v29, v12 row_ror:12 row_mask:0xf bank_mask:0x2
    v_mov_b32_dpp v30, v12 quad_perm:[0,1,2,3] row_mask:0xf bank_mask:0x4
    v_mov_b32_dpp v31, v12 row_ror:4 row_mask:0xf bank_mask:0x8
    v_mfma_f32_16x16x32_bf16 v[24:27], v[32:35], v[76:79], v[24:27]
    s_waitcnt vmcnt(5)
    s_cbranch_vccnz L_w_20
    s_bitcmp1_b32 s22, 0
    s_waitcnt vmcnt(4)
    s_cbranch_scc0 L_w_20
    s_waitcnt vmcnt(3)
L_w_20:
    buffer_load_dwordx4 v[76:79], v2, s[8:11], s15 offen offset:1024 nt
    v_add_u32 v61, 1, v61
    ds_write_b32 v62, v61 offset:240
    v_mov_b32_dpp v32, v13 row_ror:8 row_mask:0xf bank_mask:0x1
    v_mov_b32_dpp v33, v13 row_ror:12 row_mask:0xf bank_mask:0x2
    v_mov_b32_dpp v34, v13 quad_perm:[0,1,2,3] row_mask:0xf bank_mask:0x4
    v_mov_b32_dpp v35, v13 row_ror:4 row_mask:0xf bank_mask:0x8
    v_mfma_f32_16x16x32_bf16 v[24:27], v[28:31], v[80:83], v[24:27]
    s_xor_b32 s15, s16, 0x400000
    s_waitcnt lgkmcnt(1)
    v_cmp_lt_i32 vcc, s33, v63
    v_cmp_gt_i32 s[22:23], s31, v63
    ds_read_b32 v63, v62 offset:32
    s_waitcnt vmcnt(5)
    s_cbranch_vccnz L_w_21
    s_bitcmp1_b32 s22, 0
    s_waitcnt vmcnt(4)
    s_cbranch_scc0 L_w_21
    s_waitcnt vmcnt(3)
L_w_21:
    buffer_load_dwordx4 v[80:83], v2, s[8:11], s15 offen offset:0 nt
    v_mov_b32_dpp v28, v12 row_ror:4 row_mask:0xf bank_mask:0x1
    v_mov_b32_dpp v29, v12 row_ror:8 row_mask:0xf bank_mask:0x2
    v_mov_b32_dpp v30, v12 row_ror:12 row_mask:0xf bank_mask:0x4
    v_mov_b32_dpp v31, v12 quad_perm:[0,1,2,3] row_mask:0xf bank_mask:0x8
    v_mfma_f32_16x16x32_bf16 v[24:27], v[32:35], v[84:87], v[24:27]
    s_waitcnt vmcnt(5)
    s_cbranch_vccnz L_w_22
    s_bitcmp1_b32 s22, 0
    s_waitcnt vmcnt(4)
    s_cbranch_scc0 L_w_22
    s_waitcnt vmcnt(3)
L_w_22:
    buffer_load_dwordx4 v[84:87], v2, s[8:11], s15 offen offset:1024 nt
    v_add_u32 v61, 1, v61
    ds_write_b32 v62, v61 offset:240
    v_mov_b32_dpp v32, v13 row_ror:4 row_mask:0xf bank_mask:0x1
    v_mov_b32_dpp v33, v13 row_ror:8 row_mask:0xf bank_mask:0x2
    v_mov_b32_dpp v34, v13 row_ror:12 row_mask:0xf bank_mask:0x4
    v_mov_b32_dpp v35, v13 quad_perm:[0,1,2,3] row_mask:0xf bank_mask:0x8
    v_mfma_f32_16x16x32_bf16 v[24:27], v[28:31], v[88:91], v[24:27]
    s_xor_b32 s15, s16, 0x600000
    s_waitcnt lgkmcnt(1)
    v_cmp_lt_i32 vcc, s33, v63
    v_cmp_gt_i32 s[22:23], s31, v63
    ds_read_b32 v63, v62 offset:32
    s_waitcnt vmcnt(5)
    s_cbranch_vccnz L_w_23
    s_bitcmp1_b32 s22, 0
    s_waitcnt vmcnt(4)
    s_cbranch_scc0 L_w_23
    s_waitcnt vmcnt(3)
L_w_23:
    buffer_load_dwordx4 v[88:91], v2, s[8:11], s15 offen offset:0 nt
    v_mfma_f32_16x16x32_bf16 v[24:27], v[32:35], v[92:95], v[24:27]
    s_waitcnt vmcnt(5)
    s_cbranch_vccnz L_w_24
    s_bitcmp1_b32 s22, 0
    s_waitcnt vmcnt(4)
    s_cbranch_scc0 L_w_24
    s_waitcnt vmcnt(3)
L_w_24:
    buffer_load_dwordx4 v[92:95], v2, s[8:11], s15 offen offset:1024 nt
    v_add_u32 v61, 1, v61
    ds_write_b32 v62, v61 offset:240
    s_add_u32 s14, s14, 1
    s_bfe_u32 s15, s14, 0x10000
    s_lshl_b32 s15, s15, 23
    s_xor_b32 s16, s30, s15
    s_bfe_u32 s15, s14, 0x40001
    s_lshl_b32 s15, s15, 17
    s_xor_b32 s16, s16, s15
    s_waitcnt lgkmcnt(1)
    v_sub_f32 v10, v57, v7
    v_mul_f32 v10, s19, v10
    v_exp_f32 v10, v10
    ds_read_u16_d16_hi v57, v14 offset:384
    v_cvt_pk_bf16_f32 v10, v10, v10
    s_nop 1
    v_and_b32_dpp v12, v10, v6 quad_perm:[0,0,1,1] row_mask:0xf bank_mask:0xf
    v_and_b32_dpp v13, v10, v6 quad_perm:[2,2,3,3] row_mask:0xf bank_mask:0xf
    s_nop 0
    v_mov_b32_dpp v28, v12 quad_perm:[0,1,2,3] row_mask:0xf bank_mask:0x1
    v_mov_b32_dpp v29, v12 row_ror:4 row_mask:0xf bank_mask:0x2
    v_mov_b32_dpp v30, v12 row_ror:8 row_mask:0xf bank_mask:0x4
    v_mov_b32_dpp v31, v12 row_ror:12 row_mask:0xf bank_mask:0x8
    v_mov_b32_dpp v32, v13 quad_perm:[0,1,2,3] row_mask:0xf bank_mask:0x1
    v_mov_b32_dpp v33, v13 row_ror:4 row_mask:0xf bank_mask:0x2
    v_mov_b32_dpp v34, v13 row_ror:8 row_mask:0xf bank_mask:0x4
    v_mov_b32_dpp v35, v13 row_ror:12 row_mask:0xf bank_mask:0x8
    v_mfma_f32_16x16x32_bf16 v[24:27], v[28:31], v[96:99], v[24:27]
    s_waitcnt lgkmcnt(1)
    v_cmp_lt_i32 vcc, s33, v63
    v_cmp_gt_i32 s[22:23], s31, v63
    ds_read_b32 v63, v62 offset:32
    s_waitcnt vmcnt(5)
    s_cbranch_vccnz L_w_25
    s_bitcmp1_b32 s22, 0
    s_waitcnt vmcnt(4)
    s_cbranch_scc0 L_w_25
    s_waitcnt vmcnt(3)
L_w_25:
    buffer_load_dwordx4 v[96:99], v2, s[8:11], s16 offen offset:0 nt
    v_mov_b32_dpp v28, v12 row_ror:12 row_mask:0xf bank_mask:0x1
    v_mov_b32_dpp v29, v12 quad_perm:[0,1,2,3] row_mask:0xf bank_mask:0x2
    v_mov_b32_dpp v30, v12 row_ror:4 row_mask:0xf bank_mask:0x4
    v_mov_b32_dpp v31, v12 row_ror:8 row_mask:0xf bank_mask:0x8
    v_mfma_f32_16x16x32_bf16 v[24:27], v[32:35], v[100:103], v[24:27]
    s_waitcnt vmcnt(5)
    s_cbranch_vccnz L_w_26
    s_bitcmp1_b32 s22, 0
    s_waitcnt vmcnt(4)
    s_cbranch_scc0 L_w_26
    s_waitcnt vmcnt(3)
L_w_26:
    buffer_load_dwordx4 v[100:103], v2, s[8:11], s16 offen offset:1024 nt
    v_add_u32 v61, 1, v61
    ds_write_b32 v62, v61 offset:240
    v_mov_b32_dpp v32, v13 row_ror:12 row_mask:0xf bank_mask:0x1
    v_mov_b32_dpp v33, v13 quad_perm:[0,1,2,3] row_mask:0xf bank_mask:0x2
    v_mov_b32_dpp v34, v13 row_ror:4 row_mask:0xf bank_mask:0x4
    v_mov_b32_dpp v35, v13 row_ror:8 row_mask:0xf bank_mask:0x8
    v_mfma_f32_16x16x32_bf16 v[24:27], v[28:31], v[104:107], v[24:27]
    s_xor_b32 s15, s16, 0x200000
    s_waitcnt lgkmcnt(1)
    v_cmp_lt_i32 vcc, s33, v63
    v_cmp_gt_i32 s[22:23], s31, v63
    ds_read_b32 v63, v62 offset:32
    s_waitcnt vmcnt(5)
    s_cbranch_vccnz L_w_27
    s_bitcmp1_b32 s22, 0
    s_waitcnt vmcnt(4)
    s_cbranch_scc0 L_w_27
    s_waitcnt vmcnt(3)
L_w_27:
    buffer_load_dwordx4 v[104:107], v2, s[8:11], s15 offen offset:0 nt
    v_mov_b32_dpp v28, v12 row_ror:8 row_mask:0xf bank_mask:0x1
    v_mov_b32_dpp v29, v12 row_ror:12 row_mask:0xf bank_mask:0x2
    v_mov_b32_dpp v30, v12 quad_perm:[0,1,2,3] row_mask:0xf bank_mask:0x4
    v_mov_b32_dpp v31, v12 row_ror:4 row_mask:0xf bank_mask:0x8
    v_mfma_f32_16x16x32_bf16 v[24:27], v[32:35], v[108:111], v[24:27]
    s_waitcnt vmcnt(5)
    s_cbranch_vccnz L_w_28
    s_bitcmp1_b32 s22, 0
    s_waitcnt vmcnt(4)
    s_cbranch_scc0 L_w_28
    s_waitcnt vmcnt(3)
L_w_28:
    buffer_load_dwordx4 v[108:111], v2, s[8:11], s15 offen offset:1024 nt
    v_add_u32 v61, 1, v61
    ds_write_b32 v62, v61 offset:240
    v_mov_b32_dpp v32, v13 row_ror:8 row_mask:0xf bank_mask:0x1
    v_mov_b32_dpp v33, v13 row_ror:12 row_mask:0xf bank_mask:0x2
    v_mov_b32_dpp v34, v13 quad_perm:[0,1,2,3] row_mask:0xf bank_mask:0x4
    v_mov_b32_dpp v35, v13 row_ror:4 row_mask:0xf bank_mask:0x8
    v_mfma_f32_16x16x32_bf16 v[24:27], v[28:31], v[112:115], v[24:27]
    s_xor_b32 s15, s16, 0x400000
    s_waitcnt lgkmcnt(1)
    v_cmp_lt_i32 vcc, s33, v63
    v_cmp_gt_i32 s[22:23], s31, v63
    ds_read_b32 v63, v62 offset:32
    s_waitcnt vmcnt(5)
    s_cbranch_vccnz L_w_29
    s_bitcmp1_b32 s22, 0
    s_waitcnt vmcnt(4)
    s_cbranch_scc0 L_w_29
    s_waitcnt vmcnt(3)
L_w_29:
    buffer_load_dwordx4 v[112:115], v2, s[8:11], s15 offen offset:0 nt
    v_mov_b32_dpp v28, v12 row_ror:4 row_mask:0xf bank_mask:0x1
    v_mov_b32_dpp v29, v12 row_ror:8 row_mask:0xf bank_mask:0x2
    v_mov_b32_dpp v30, v12 row_ror:12 row_mask:0xf bank_mask:0x4
    v_mov_b32_dpp v31, v12 quad_perm:[0,1,2,3] row_mask:0xf bank_mask:0x8
    v_mfma_f32_16x16x32_bf16 v[24:27], v[32:35], v[116:119], v[24:27]
    s_waitcnt vmcnt(5)
    s_cbranch_vccnz L_w_30
    s_bitcmp1_b32 s22, 0
    s_waitcnt vmcnt(4)
    s_cbranch_scc0 L_w_30
    s_waitcnt vmcnt(3)
L_w_30:
    buffer_load_dwordx4 v[116:119], v2, s[8:11], s15 offen offset:1024 nt
    v_add_u32 v61, 1, v61
    ds_write_b32 v62, v61 offset:240
    v_mov_b32_dpp v32, v13 row_ror:4 row_mask:0xf bank_mask:0x1
    v_mov_b32_dpp v33, v13 row_ror:8 row_mask:0xf bank_mask:0x2
    v_mov_b32_dpp v34, v13 row_ror:12 row_mask:0xf bank_mask:0x4
    v_mov_b32_dpp v35, v13 quad_perm:[0,1,2,3] row_mask:0xf bank_mask:0x8
    v_mfma_f32_16x16x32_bf16 v[24:27], v[28:31], v[120:123], v[24:27]
    s_xor_b32 s15, s16, 0x600000
    s_waitcnt lgkmcnt(1)
    v_cmp_lt_i32 vcc, s33, v63
    v_cmp_gt_i32 s[22:23], s31, v63
    ds_read_b32 v63, v62 offset:32
    s_waitcnt vmcnt(5)
    s_cbranch_vccnz L_w_31
    s_bitcmp1_b32 s22, 0
    s_waitcnt vmcnt(4)
    s_cbranch_scc0 L_w_31
    s_waitcnt vmcnt(3)
L_w_31:
    buffer_load_dwordx4 v[120:123], v2, s[8:11], s15 offen offset:0 nt
    v_mfma_f32_16x16x32_bf16 v[24:27], v[32:35], v[124:127], v[24:27]
    s_waitcnt vmcnt(5)
    s_cbranch_vccnz L_w_32
    s_bitcmp1_b32 s22, 0
    s_waitcnt vmcnt(4)
    s_cbranch_scc0 L_w_32
    s_waitcnt vmcnt(3)
L_w_32:
    buffer_load_dwordx4 v[124:127], v2, s[8:11], s15 offen offset:1024 nt
    v_add_u32 v61, 1, v61
    ds_write_b32 v62, v61 offset:240
    s_add_u32 s14, s14, 1
    s_bfe_u32 s15, s14, 0x10000
    s_lshl_b32 s15, s15, 23
    s_xor_b32 s16, s30, s15
    s_bfe_u32 s15, s14, 0x40001
    s_lshl_b32 s15, s15, 17
    s_xor_b32 s16, s16, s15
    v_add_u32 v14, 256, v14
    s_sub_u32 s17, s17, 1
    s_cmp_lg_u32 s17, 0
    s_cbranch_scc1 L_vloop
    s_waitcnt lgkmcnt(1)
    v_sub_f32 v10, v56, v7
    v_mul_f32 v10, s19, v10
    v_exp_f32 v10, v10
    s_nop 0
    v_cvt_pk_bf16_f32 v10, v10, v10
    s_nop 1
    v_and_b32_dpp v12, v10, v6 quad_perm:[0,0,1,1] row_mask:0xf bank_mask:0xf
    v_and_b32_dpp v13, v10, v6 quad_perm:[2,2,3,3] row_mask:0xf bank_mask:0xf
    s_nop 0
    v_mov_b32_dpp v28, v12 quad_perm:[0,1,2,3] row_mask:0xf bank_mask:0x1
    v_mov_b32_dpp v29, v12 row_ror:4 row_mask:0xf bank_mask:0x2
    v_mov_b32_dpp v30, v12 row_ror:8 row_mask:0xf bank_mask:0x4
    v_mov_b32_dpp v31, v12 row_ror:12 row_mask:0xf bank_mask:0x8
    v_mov_b32_dpp v32, v13 quad_perm:[0,1,2,3] row_mask:0xf bank_mask:0x1
    v_mov_b32_dpp v33, v13 row_ror:4 row_mask:0xf bank_mask:0x2
    v_mov_b32_dpp v34, v13 row_ror:8 row_mask:0xf bank_mask:0x4
    v_mov_b32_dpp v35, v13 row_ror:12 row_mask:0xf bank_mask:0x8
    v_mfma_f32_16x16x32_bf16 v[24:27], v[28:31], v[64:67], v[24:27]
    v_mov_b32_dpp v28, v12 row_ror:12 row_mask:0xf bank_mask:0x1
    v_mov_b32_dpp v29, v12 quad_perm:[0,1,2,3] row_mask:0xf bank_mask:0x2
    v_mov_b32_dpp v30, v12 row_ror:4 row_mask:0xf bank_mask:0x4
    v_mov_b32_dpp v31, v12 row_ror:8 row_mask:0xf bank_mask:0x8
    v_mfma_f32_16x16x32_bf16 v[24:27], v[32:35], v[68:71], v[24:27]
    v_mov_b32_dpp v32, v13 row_ror:12 row_mask:0xf bank_mask:0x1
    v_mov_b32_dpp v33, v13 quad_perm:[0,1,2,3] row_mask:0xf bank_mask:0x2
    v_mov_b32_dpp v34, v13 row_ror:4 row_mask:0xf bank_mask:0x4
    v_mov_b32_dpp v35, v13 row_ror:8 row_mask:0xf bank_mask:0x8
    v_mfma_f32_16x16x32_bf16 v[24:27], v[28:31], v[72:75], v[24:27]
    v_mov_b32_dpp v28, v12 row_ror:8 row_mask:0xf bank_mask:0x1
    v_mov_b32_dpp v29, v12 row_ror:12 row_mask:0xf bank_mask:0x2
    v_mov_b32_dpp v30, v12 quad_perm:[0,1,2,3] row_mask:0xf bank_mask:0x4
    v_mov_b32_dpp v31, v12 row_ror:4 row_mask:0xf bank_mask:0x8
    v_mfma_f32_16x16x32_bf16 v[24:27], v[32:35], v[76:79], v[24:27]
    v_mov_b32_dpp v32, v13 row_ror:8 row_mask:0xf bank_mask:0x1
    v_mov_b32_dpp v33, v13 row_ror:12 row_mask:0xf bank_mask:0x2
    v_mov_b32_dpp v34, v13 quad_perm:[0,1,2,3] row_mask:0xf bank_mask:0x4
    v_mov_b32_dpp v35, v13 row_ror:4 row_mask:0xf bank_mask:0x8
    v_mfma_f32_16x16x32_bf16 v[24:27], v[28:31], v[80:83], v[24:27]
    v_mov_b32_dpp v28, v12 row_ror:4 row_mask:0xf bank_mask:0x1
    v_mov_b32_dpp v29, v12 row_ror:8 row_mask:0xf bank_mask:0x2
    v_mov_b32_dpp v30, v12 row_ror:12 row_mask:0xf bank_mask:0x4
    v_mov_b32_dpp v31, v12 quad_perm:[0,1,2,3] row_mask:0xf bank_mask:0x8
    v_mfma_f32_16x16x32_bf16 v[24:27], v[32:35], v[84:87], v[24:27]
    v_mov_b32_dpp v32, v13 row_ror:4 row_mask:0xf bank_mask:0x1
    v_mov_b32_dpp v33, v13 row_ror:8 row_mask:0xf bank_mask:0x2
    v_mov_b32_dpp v34, v13 row_ror:12 row_mask:0xf bank_mask:0x4
    v_mov_b32_dpp v35, v13 quad_perm:[0,1,2,3] row_mask:0xf bank_mask:0x8
    v_mfma_f32_16x16x32_bf16 v[24:27], v[28:31], v[88:91], v[24:27]
    s_nop 0
    v_mfma_f32_16x16x32_bf16 v[24:27], v[32:35], v[92:95], v[24:27]
    s_waitcnt lgkmcnt(0)
    v_sub_f32 v10, v57, v7
    v_mul_f32 v10, s19, v10
    v_exp_f32 v10, v10
    s_nop 0
    v_cvt_pk_bf16_f32 v10, v10, v10
    s_nop 1
    v_and_b32_dpp v12, v10, v6 quad_perm:[0,0,1,1] row_mask:0xf bank_mask:0xf
    v_and_b32_dpp v13, v10, v6 quad_perm:[2,2,3,3] row_mask:0xf bank_mask:0xf
    s_nop 0
    v_mov_b32_dpp v28, v12 quad_perm:[0,1,2,3] row_mask:0xf bank_mask:0x1
    v_mov_b32_dpp v29, v12 row_ror:4 row_mask:0xf bank_mask:0x2
    v_mov_b32_dpp v30, v12 row_ror:8 row_mask:0xf bank_mask:0x4
    v_mov_b32_dpp v31, v12 row_ror:12 row_mask:0xf bank_mask:0x8
    v_mov_b32_dpp v32, v13 quad_perm:[0,1,2,3] row_mask:0xf bank_mask:0x1
    v_mov_b32_dpp v33, v13 row_ror:4 row_mask:0xf bank_mask:0x2
    v_mov_b32_dpp v34, v13 row_ror:8 row_mask:0xf bank_mask:0x4
    v_mov_b32_dpp v35, v13 row_ror:12 row_mask:0xf bank_mask:0x8
    v_mfma_f32_16x16x32_bf16 v[24:27], v[28:31], v[96:99], v[24:27]
    v_mov_b32_dpp v28, v12 row_ror:12 row_mask:0xf bank_mask:0x1
    v_mov_b32_dpp v29, v12 quad_perm:[0,1,2,3] row_mask:0xf bank_mask:0x2
    v_mov_b32_dpp v30, v12 row_ror:4 row_mask:0xf bank_mask:0x4
    v_mov_b32_dpp v31, v12 row_ror:8 row_mask:0xf bank_mask:0x8
    s_lshl_b32 s21, s3, 10
    v_add_u32 v1, s21, v4
    s_lshl_b32 s20, s3, 3
    v_mov_b32 v2, s20
    s_lshl_b32 s22, s34, 10
    s_add_u32 s22, s22, 131072
    v_mov_b32 v11, 0xffffff00
    s_add_u32 s96, s35, 0x7f4a7c15
    s_mul_i32 s96, s96, 0x9e3779b1
    s_lshr_b32 s97, s96, 15
    s_xor_b32 s96, s96, s97
    s_mul_i32 s96, s96, 0x85ebca77
    s_lshr_b32 s97, s96, 13
    s_xor_b32 s96, s96, s97
    s_mul_i32 s96, s96, 0xc2b2ae3d
    s_lshr_b32 s97, s96, 16
    s_xor_b32 s96, s96, s97
    s_or_b32 s96, s96, 0x01010101
    s_xor_b32 s35, s35, s96
    s_and_b32 s96, s35, 0xff
    s_bfe_u32 s97, s35, 0x80008
    s_bfe_u32 s98, s35, 0x80010
    s_lshr_b32 s99, s35, 24
L_fwait:
    ds_read_b32 v3, v60 offset:28
    ds_read_b64 v[8:9], v2 offset:192
    s_waitcnt lgkmcnt(0)
    v_readfirstlane_b32 s23, v3
    s_nop 0
    s_cmp_eq_u32 s23, 0
    s_cbranch_scc1 L_fwait
    v_mfma_f32_16x16x32_bf16 v[24:27], v[32:35], v[100:103], v[24:27]
    v_mov_b32_dpp v32, v13 row_ror:12 row_mask:0xf bank_mask:0x1
    v_mov_b32_dpp v33, v13 quad_perm:[0,1,2,3] row_mask:0xf bank_mask:0x2
    v_mov_b32_dpp v34, v13 row_ror:4 row_mask:0xf bank_mask:0x4
    v_mov_b32_dpp v35, v13 row_ror:8 row_mask:0xf bank_mask:0x8
    s_waitcnt vmcnt(5)
    v_mfma_f32_16x16x32_bf16 v[24:27], v[28:31], v[104:107], v[24:27]
    v_mov_b32_dpp v28, v12 row_ror:8 row_mask:0xf bank_mask:0x1
    v_mov_b32_dpp v29, v12 row_ror:12 row_mask:0xf bank_mask:0x2
    v_mov_b32_dpp v30, v12 quad_perm:[0,1,2,3] row_mask:0xf bank_mask:0x4
    v_mov_b32_dpp v31, v12 row_ror:4 row_mask:0xf bank_mask:0x8
    s_waitcnt vmcnt(4)
    v_mfma_f32_16x16x32_bf16 v[24:27], v[32:35], v[108:111], v[24:27]
    v_mov_b32_dpp v32, v13 row_ror:8 row_mask:0xf bank_mask:0x1
    v_mov_b32_dpp v33, v13 row_ror:12 row_mask:0xf bank_mask:0x2
    v_mov_b32_dpp v34, v13 quad_perm:[0,1,2,3] row_mask:0xf bank_mask:0x4
    v_mov_b32_dpp v35, v13 row_ror:4 row_mask:0xf bank_mask:0x8
    s_waitcnt vmcnt(3)
    v_mfma_f32_16x16x32_bf16 v[24:27], v[28:31], v[112:115], v[24:27]
    v_mov_b32_dpp v28, v12 row_ror:4 row_mask:0xf bank_mask:0x1
    v_mov_b32_dpp v29, v12 row_ror:8 row_mask:0xf bank_mask:0x2
    v_mov_b32_dpp v30, v12 row_ror:12 row_mask:0xf bank_mask:0x4
    v_mov_b32_dpp v31, v12 quad_perm:[0,1,2,3] row_mask:0xf bank_mask:0x8
    s_waitcnt vmcnt(2)
    v_mfma_f32_16x16x32_bf16 v[24:27], v[32:35], v[116:119], v[24:27]
    v_mov_b32_dpp v32, v13 row_ror:4 row_mask:0xf bank_mask:0x1
    v_mov_b32_dpp v33, v13 row_ror:8 row_mask:0xf bank_mask:0x2
    v_mov_b32_dpp v34, v13 row_ror:12 row_mask:0xf bank_mask:0x4
    v_mov_b32_dpp v35, v13 quad_perm:[0,1,2,3] row_mask:0xf bank_mask:0x8
    s_waitcnt vmcnt(1)
    v_mfma_f32_16x16x32_bf16 v[24:27], v[28:31], v[120:123], v[24:27]
    s_waitcnt vmcnt(0)
    v_mfma_f32_16x16x32_bf16 v[24:27], v[32:35], v[124:127], v[24:27]
    s_nop 7
    v_mul_f32 v24, v24, v8
    v_mul_f32 v25, v25, v8
    v_mul_f32 v26, v26, v9
    v_mul_f32 v27, v27, v9
    ds_write_b128 v1, v[24:27] offset:6144
    s_mov_b64 exec, 1
    ds_add_rtn_u32 v9, v60, v59 offset:12
    s_mov_b64 exec, -1
    ds_read_b128 v[64:67], v4 offset:6144
    ds_read_b128 v[68:71], v4 offset:7168
    ds_read_b128 v[72:75], v4 offset:8192
    ds_read_b128 v[76:79], v4 offset:9216
    s_waitcnt lgkmcnt(2)
    v_readfirstlane_b32 s20, v9
    v_pk_add_f32 v[64:65], v[64:65], v[68:69]
    v_pk_add_f32 v[66:67], v[66:67], v[70:71]
    s_cmp_lg_u32 s20, 3
    s_cbranch_scc1 L_sdone
    s_waitcnt lgkmcnt(0)
    v_pk_add_f32 v[72:73], v[72:73], v[76:77]
    v_pk_add_f32 v[74:75], v[74:75], v[78:79]
    s_cmp_eq_u32 s23, 2
    v_pk_add_f32 v[64:65], v[64:65], v[72:73]
    v_pk_add_f32 v[66:67], v[66:67], v[74:75]
    v_and_or_b32 v64, v64, v11, s96
    v_and_or_b32 v65, v65, v11, s97
    v_and_or_b32 v66, v66, v11, s98
    v_and_or_b32 v67, v67, v11, s99
    s_cbranch_scc0 L_h1far
    buffer_store_dwordx4 v[64:67], v4, s[24:27], s22 offen
    s_branch L_h1done
L_h1far:
    buffer_store_dwordx4 v[64:67], v4, s[24:27], s22 offen sc1
L_h1done:
    ds_write_b32 v60, v59 offset:236
L_sdone:
    s_endpgm
L_service:
    s_load_dwordx4 s[60:63], s[0:1], 24
    s_load_dwordx4 s[68:71], s[0:1], 64
    s_mov_b32 s89, 2
    s_cmpk_ge_u32 s3, 0x180
    s_cbranch_scc1 L_svc23
    s_and_b32 s32, s2, 7
    s_lshr_b32 s86, s2, 5
    s_lshl3_add_u32 s87, s32, s86
    s_lshl3_add_u32 s80, s86, s32
    s_bfe_u32 s86, s2, 0x10003
    s_cselect_b32 s80, s80, s87
    s_cselect_b32 s87, 45, 64
    s_cselect_b32 s78, 27, 32
    s_cmp_ge_u32 s80, s87
    s_cbranch_scc1 L_svc_join
    s_mov_b32 s89, s86
    s_lshl_b32 s78, s78, 8
    s_bfe_u32 s31, s2, 0x10004
    s_bfe_u32 s29, s3, 0x10006
    s_lshl1_add_u32 s29, s31, s29
    v_bfe_u32 v1, v0, 4, 2
    v_lshl_add_u32 v1, s29, 2, v1
    s_mul_i32 s86, s78, 36
    v_mul_lo_u32 v1, v1, s86
    v_and_b32 v2, 15, v0
    v_lshl_add_u32 v1, v2, 3, v1
    s_lshl_b32 s79, s80, 7
    s_mul_i32 s38, s78, 576
    s_mov_b32 s39, 0x20000
    s_cmp_eq_u32 s89, 1
    s_waitcnt lgkmcnt(0)
    s_cselect_b32 s36, s70, s60
    s_cselect_b32 s37, s71, s61
    buffer_load_dwordx2 v[132:133], v1, s[36:39], s79 offen nt
    s_add_u32 s79, s79, s78
    buffer_load_dwordx2 v[134:135], v1, s[36:39], s79 offen nt
    s_add_u32 s79, s79, s78
    buffer_load_dwordx2 v[136:137], v1, s[36:39], s79 offen nt
    s_add_u32 s79, s79, s78
    buffer_load_dwordx2 v[138:139], v1, s[36:39], s79 offen nt
    s_add_u32 s79, s79, s78
    buffer_load_dwordx2 v[140:141], v1, s[36:39], s79 offen nt
    s_add_u32 s79, s79, s78
    buffer_load_dwordx2 v[142:143], v1, s[36:39], s79 offen nt
    s_add_u32 s79, s79, s78
    buffer_load_dwordx2 v[144:145], v1, s[36:39], s79 offen nt
    s_add_u32 s79, s79, s78
    buffer_load_dwordx2 v[146:147], v1, s[36:39], s79 offen nt
    s_add_u32 s79, s79, s78
    buffer_load_dwordx2 v[148:149], v1, s[36:39], s79 offen nt
    s_add_u32 s79, s79, s78
    buffer_load_dwordx2 v[150:151], v1, s[36:39], s79 offen nt
    s_add_u32 s79, s79, s78
    buffer_load_dwordx2 v[152:153], v1, s[36:39], s79 offen nt
    s_add_u32 s79, s79, s78
    buffer_load_dwordx2 v[154:155], v1, s[36:39], s79 offen nt
    s_add_u32 s79, s79, s78
    buffer_load_dwordx2 v[156:157], v1, s[36:39], s79 offen nt
    s_add_u32 s79, s79, s78
    buffer_load_dwordx2 v[158:159], v1, s[36:39], s79 offen nt
    s_add_u32 s79, s79, s78
    buffer_load_dwordx2 v[160:161], v1, s[36:39], s79 offen nt
    s_add_u32 s79, s79, s78
    buffer_load_dwordx2 v[162:163], v1, s[36:39], s79 offen nt
    s_add_u32 s79, s79, s78
    buffer_load_dwordx2 v[164:165], v1, s[36:39], s79 offen nt
    s_add_u32 s79, s79, s78
    buffer_load_dwordx2 v[166:167], v1, s[36:39], s79 offen nt
    s_add_u32 s79, s79, s78
    buffer_load_dwordx2 v[168:169], v1, s[36:39], s79 offen nt
    s_add_u32 s79, s79, s78
    buffer_load_dwordx2 v[170:171], v1, s[36:39], s79 offen nt
    s_add_u32 s79, s79, s78
    buffer_load_dwordx2 v[172:173], v1, s[36:39], s79 offen nt
    s_add_u32 s79, s79, s78
    buffer_load_dwordx2 v[174:175], v1, s[36:39], s79 offen nt
    s_add_u32 s79, s79, s78
    buffer_load_dwordx2 v[176:177], v1, s[36:39], s79 offen nt
    s_add_u32 s79, s79, s78
    buffer_load_dwordx2 v[178:179], v1, s[36:39], s79 offen nt
    s_add_u32 s79, s79, s78
    buffer_load_dwordx2 v[180:181], v1, s[36:39], s79 offen nt
    s_add_u32 s79, s79, s78
    buffer_load_dwordx2 v[182:183], v1, s[36:39], s79 offen nt
    s_add_u32 s79, s79, s78
    buffer_load_dwordx2 v[184:185], v1, s[36:39], s79 offen nt
    s_add_u32 s79, s79, s78
    buffer_load_dwordx2 v[186:187], v1, s[36:39], s79 offen nt
    s_add_u32 s79, s79, s78
    buffer_load_dwordx2 v[188:189], v1, s[36:39], s79 offen nt
    s_add_u32 s79, s79, s78
    buffer_load_dwordx2 v[190:191], v1, s[36:39], s79 offen nt
    s_add_u32 s79, s79, s78
    buffer_load_dwordx2 v[192:193], v1, s[36:39], s79 offen nt
    s_add_u32 s79, s79, s78
    buffer_load_dwordx2 v[194:195], v1, s[36:39], s79 offen nt
    s_add_u32 s79, s79, s78
    buffer_load_dwordx2 v[196:197], v1, s[36:39], s79 offen nt
    s_add_u32 s79, s79, s78
    buffer_load_dwordx2 v[198:199], v1, s[36:39], s79 offen nt
    s_add_u32 s79, s79, s78
    buffer_load_dwordx2 v[200:201], v1, s[36:39], s79 offen nt
    s_add_u32 s79, s79, s78
    buffer_load_dwordx2 v[202:203], v1, s[36:39], s79 offen nt
    s_branch L_svc_join
L_svc23:
    v_and_b32 v0, 63, v0
    v_mov_b32 v1, 0
    v_lshlrev_b32 v2, 2, v0
    ds_write_b32 v2, v1
    s_cmpk_lt_u32 s3, 0x1c0
    s_cbranch_scc1 L_svc_join
    s_cmpk_lt_u32 s2, 232
    s_cbranch_scc1 L_svc_join
    s_getpc_b64 s[86:87]
L_pc_33:
    s_add_u32 s86, s86, adaLN_cond__gqa_block_cached__dense_activation_relu__decode_kernel-L_pc_33
    s_addc_u32 s87, s87, -1
    v_lshlrev_b32 v8, 7, v0
    v_min_u32 v4, L_end-adaLN_cond__gqa_block_cached__dense_activation_relu__decode_kernel, v8
    v_mov_b32 v5, s87
    v_add_co_u32 v4, vcc, s86, v4
    s_nop 1
    v_addc_co_u32 v5, vcc, 0, v5, vcc
    global_load_dword v6, v[4:5], off
    v_add_u32 v8, 0x2000, v8
    v_min_u32 v4, L_end-adaLN_cond__gqa_block_cached__dense_activation_relu__decode_kernel, v8
    v_mov_b32 v5, s87
    v_add_co_u32 v4, vcc, s86, v4
    s_nop 1
    v_addc_co_u32 v5, vcc, 0, v5, vcc
    global_load_dword v6, v[4:5], off
    v_add_u32 v8, 0x2000, v8
    v_min_u32 v4, L_end-adaLN_cond__gqa_block_cached__dense_activation_relu__decode_kernel, v8
    v_mov_b32 v5, s87
    v_add_co_u32 v4, vcc, s86, v4
    s_nop 1
    v_addc_co_u32 v5, vcc, 0, v5, vcc
    global_load_dword v6, v[4:5], off
    v_add_u32 v8, 0x2000, v8
    v_min_u32 v4, L_end-adaLN_cond__gqa_block_cached__dense_activation_relu__decode_kernel, v8
    v_mov_b32 v5, s87
    v_add_co_u32 v4, vcc, s86, v4
    s_nop 1
    v_addc_co_u32 v5, vcc, 0, v5, vcc
    global_load_dword v6, v[4:5], off
    v_add_u32 v8, 0x2000, v8
L_svc_join:
    s_load_dwordx2 s[56:57], s[0:1], 0
    s_load_dwordx4 s[64:67], s[0:1], 48
    s_load_dwordx2 s[72:73], s[0:1], 80
    s_load_dwordx2 s[76:77], s[0:1], 96
    s_waitcnt lgkmcnt(0)
    s_barrier
    s_load_dword s35, s[76:77], 0
    v_and_b32 v0, 63, v0
    s_lshr_b32 s3, s3, 6
    s_mov_b32 s19, 0x3fb8aa3b
    s_and_b32 s34, s2, 7
    s_lshl_b32 s34, s34, 5
    s_and_b32 s17, s2, 8
    s_lshl_b32 s17, s17, 1
    s_or_b32 s34, s34, s17
    s_lshr_b32 s17, s2, 4
    s_or_b32 s34, s34, s17
    s_sub_u32 s33, s3, 4
    v_lshrrev_b32 v244, 4, v0
    v_and_b32 v245, 15, v0
    v_lshlrev_b32 v14, 4, v0
    s_mov_b32 s39, 0x20000
    s_mov_b32 s40, s76
    s_mov_b32 s41, s77
    s_mov_b32 s42, 2097152
    s_mov_b32 s43, 0x20000
    s_cmp_eq_u32 s89, 1
    s_cselect_b32 s44, s68, s56
    s_cselect_b32 s45, s69, s57
    s_mov_b32 s46, 1152
    s_mov_b32 s47, 0x20000
    s_mov_b32 s48, s72
    s_mov_b32 s49, s73
    s_mov_b32 s50, 1152
    s_mov_b32 s51, 0x20000
    s_mov_b32 s58, 16384
    s_mov_b32 s81, 0
    s_mov_b32 s82, 0x05040100
    s_mov_b32 s83, 0x07060302
    s_mov_b32 s84, -1
    s_mov_b32 s85, 15
    s_mul_i32 s86, s33, 320
    s_add_u32 s86, s86, 768
    v_lshl_add_u32 v246, v0, 3, s86
    v_mul_u32_u24 v1, 72, v244
    v_add_u32 v247, s86, v1
    s_lshl_b32 s86, s33, 8
    v_add_u32 v248, s86, v14
    s_cmp_eq_u32 s89, 2
    s_cbranch_scc1 L_norole
    v_mov_b32 v204, 0
    v_mov_b32 v205, 0
    v_mov_b32 v206, 0
    v_mov_b32 v207, 0
    v_mov_b32 v208, 0
    v_mov_b32 v209, 0
    v_mov_b32 v210, 0
    v_mov_b32 v211, 0
    s_mov_b64 exec, s[84:85]
    v_lshlrev_b32 v2, 3, v0
    s_add_u32 s86, s29, 0
    s_and_b32 s86, s86, 3
    s_mul_i32 s86, s86, 288
    buffer_load_dwordx2 v[204:205], v2, s[44:47], s86 offen
    s_cmp_eq_u32 s89, 1
    s_cbranch_scc1 L_in_done
    s_add_u32 s86, s29, 1
    s_and_b32 s86, s86, 3
    s_mul_i32 s86, s86, 288
    buffer_load_dwordx2 v[206:207], v2, s[44:47], s86 offen
    s_add_u32 s86, s29, 2
    s_and_b32 s86, s86, 3
    s_mul_i32 s86, s86, 288
    buffer_load_dwordx2 v[208:209], v2, s[44:47], s86 offen
    s_add_u32 s86, s29, 3
    s_and_b32 s86, s86, 3
    s_mul_i32 s86, s86, 288
    buffer_load_dwordx2 v[210:211], v2, s[44:47], s86 offen
L_in_done:
    s_mov_b64 exec, -1
    s_lshl_b32 s86, s80, 2
    s_or_b32 s86, s86, s29
    s_lshl_b32 s86, s86, 2
    s_or_b32 s86, s86, s89
    s_cmp_lg_u32 s86, 1
    s_cbranch_scc1 L_nozero
    v_mul_u32_u24 v1, 0x1100, v0
    v_mov_b32 v2, 0
    v_mov_b32 v3, 0
    s_mov_b32 s86, 917504
    s_mov_b64 exec, 0xffff
    buffer_store_dwordx2 v[2:3], v1, s[40:43], s86 offen sc1
    s_mov_b64 exec, -1
L_nozero:
    s_waitcnt lgkmcnt(0)
    s_add_u32 s96, s35, 0x7f4a7c15
    s_mul_i32 s96, s96, 0x9e3779b1
    s_lshr_b32 s97, s96, 15
    s_xor_b32 s96, s96, s97
    s_mul_i32 s96, s96, 0x85ebca77
    s_lshr_b32 s97, s96, 13
    s_xor_b32 s96, s96, s97
    s_mul_i32 s96, s96, 0xc2b2ae3d
    s_lshr_b32 s97, s96, 16
    s_xor_b32 s96, s96, s97
    s_or_b32 s96, s96, 0x01010101
    s_xor_b32 s35, s35, s96
    s_and_b32 s96, s35, 0xff
    s_bfe_u32 s97, s35, 0x80008
    s_bfe_u32 s98, s35, 0x80010
    s_lshr_b32 s99, s35, 24
    s_and_b32 s24, s96, 15
    s_and_b32 s25, s97, 15
    s_and_b32 s26, s98, 15
    s_and_b32 s27, s99, 15
    s_waitcnt vmcnt(0)
    v_lshlrev_b32 v212, 16, v204
    v_and_b32 v213, 0xffff0000, v204
    v_lshlrev_b32 v214, 16, v205
    v_and_b32 v215, 0xffff0000, v205
    v_lshlrev_b32 v216, 16, v206
    v_and_b32 v217, 0xffff0000, v206
    v_lshlrev_b32 v218, 16, v207
    v_and_b32 v219, 0xffff0000, v207
    v_lshlrev_b32 v220, 16, v208
    v_and_b32 v221, 0xffff0000, v208
    v_lshlrev_b32 v222, 16, v209
    v_and_b32 v223, 0xffff0000, v209
    v_lshlrev_b32 v224, 16, v210
    v_and_b32 v225, 0xffff0000, v210
    v_lshlrev_b32 v226, 16, v211
    v_and_b32 v227, 0xffff0000, v211
    s_cmp_eq_u32 s89, 0
    s_cbranch_scc1 L_qrole
    s_mov_b64 exec, s[84:85]
    s_mov_b32 s86, 0x32a57060
    s_mov_b32 s87, 0x7f7fffff
    v_mul_f32 v4, 0xbfb8aa3b, v212
    v_mul_f32 v5, 0xbfb8aa3b, v213
    v_mul_f32 v6, 0xbfb8aa3b, v214
    v_mul_f32 v7, 0xbfb8aa3b, v215
    v_fma_f32 v8, -v212, s19, -v4
    v_fma_f32 v9, -v213, s19, -v5
    v_fma_f32 v10, -v214, s19, -v6
    v_fma_f32 v11, -v215, s19, -v7
    v_exp_f32 v4, v4
    v_exp_f32 v5, v5
    v_exp_f32 v6, v6
    v_exp_f32 v7, v7
    v_fma_f32 v8, -v212, s86, v8
    v_fma_f32 v9, -v213, s86, v9
    v_fma_f32 v10, -v214, s86, v10
    v_fma_f32 v11, -v215, s86, v11
    v_mul_f32 v8, 0x3f317218, v8
    v_mul_f32 v9, 0x3f317218, v9
    v_mul_f32 v10, 0x3f317218, v10
    v_mul_f32 v11, 0x3f317218, v11
    v_med3_f32 v8, v8, -0.5, 0.5
    v_med3_f32 v9, v9, -0.5, 0.5
    v_med3_f32 v10, v10, -0.5, 0.5
    v_med3_f32 v11, v11, -0.5, 0.5
    v_min_f32 v216, s87, v4
    v_min_f32 v217, s87, v5
    v_min_f32 v218, s87, v6
    v_min_f32 v219, s87, v7
    v_fma_f32 v4, v216, v8, v4
    v_fma_f32 v5, v217, v9, v5
    v_fma_f32 v6, v218, v10, v6
    v_fma_f32 v7, v219, v11, v7
    v_add_f32 v4, 1.0, v4
    v_add_f32 v5, 1.0, v5
    v_add_f32 v6, 1.0, v6
    v_add_f32 v7, 1.0, v7
    v_rcp_f32 v8, v4
    v_rcp_f32 v9, v5
    v_rcp_f32 v10, v6
    v_rcp_f32 v11, v7
    v_mul_f32 v216, v212, v8
    v_mul_f32 v217, v213, v9
    v_mul_f32 v218, v214, v10
    v_mul_f32 v219, v215, v11
    v_fma_f32 v220, -v216, v4, v212
    v_fma_f32 v221, -v217, v5, v213
    v_fma_f32 v222, -v218, v6, v214
    v_fma_f32 v223, -v219, v7, v215
    v_fma_f32 v216, v220, v8, v216
    v_fma_f32 v217, v221, v9, v217
    v_fma_f32 v218, v222, v10, v218
    v_fma_f32 v219, v223, v11, v219
    v_div_fixup_f32 v4, v216, v4, v212
    v_div_fixup_f32 v5, v217, v5, v213
    v_div_fixup_f32 v6, v218, v6, v214
    v_div_fixup_f32 v7, v219, v7, v215
    v_cvt_pk_bf16_f32 v2, v4, v5
    v_cvt_pk_bf16_f32 v3, v6, v7
    ds_write_b64 v246, v[2:3]
    s_mov_b64 exec, -1
    s_mov_b32 s88, 4096
    s_branch L_wperm
L_qrole:
    v_add_f32 v2, v212, v213
    v_mul_f32 v3, v212, v212
    v_fmac_f32 v3, v213, v213
    v_add_f32 v2, v2, v214
    v_fmac_f32 v3, v214, v214
    v_add_f32 v2, v2, v215
    v_fmac_f32 v3, v215, v215
    v_add_f32 v2, v2, v216
    v_fmac_f32 v3, v216, v216
    v_add_f32 v2, v2, v217
    v_fmac_f32 v3, v217, v217
    v_add_f32 v2, v2, v218
    v_fmac_f32 v3, v218, v218
    v_add_f32 v2, v2, v219
    v_fmac_f32 v3, v219, v219
    v_add_f32 v2, v2, v220
    v_fmac_f32 v3, v220, v220
    v_add_f32 v2, v2, v221
    v_fmac_f32 v3, v221, v221
    v_add_f32 v2, v2, v222
    v_fmac_f32 v3, v222, v222
    v_add_f32 v2, v2, v223
    v_fmac_f32 v3, v223, v223
    v_add_f32 v2, v2, v224
    v_fmac_f32 v3, v224, v224
    v_add_f32 v2, v2, v225
    v_fmac_f32 v3, v225, v225
    v_add_f32 v2, v2, v226
    v_fmac_f32 v3, v226, v226
    v_add_f32 v2, v2, v227
    v_fmac_f32 v3, v227, v227
    s_nop 0
    v_add_f32_dpp v2, v2, v2 quad_perm:[1,0,3,2] row_mask:0xf bank_mask:0xf
    v_add_f32_dpp v3, v3, v3 quad_perm:[1,0,3,2] row_mask:0xf bank_mask:0xf
    s_nop 0
    v_add_f32_dpp v2, v2, v2 quad_perm:[2,3,0,1] row_mask:0xf bank_mask:0xf
    v_add_f32_dpp v3, v3, v3 quad_perm:[2,3,0,1] row_mask:0xf bank_mask:0xf
    s_nop 0
    v_add_f32_dpp v2, v2, v2 row_ror:4 row_mask:0xf bank_mask:0xf
    v_add_f32_dpp v3, v3, v3 row_ror:4 row_mask:0xf bank_mask:0xf
    s_nop 0
    v_add_f32_dpp v2, v2, v2 row_ror:8 row_mask:0xf bank_mask:0xf
    v_add_f32_dpp v3, v3, v3 row_ror:8 row_mask:0xf bank_mask:0xf
    v_mov_b32 v4, v2
    v_mov_b32 v5, v3
    s_nop 0
    v_permlane16_swap_b32 v2, v4
    v_permlane16_swap_b32 v3, v5
    v_add_f32 v2, v2, v4
    v_add_f32 v3, v3, v5
    v_mov_b32 v4, v2
    v_mov_b32 v5, v3
    s_nop 0
    v_permlane32_swap_b32 v2, v4
    v_permlane32_swap_b32 v3, v5
    v_add_f32 v2, v2, v4
    v_add_f32 v3, v3, v5
    v_mul_f32 v2, 0x3ae38e39, v2
    v_mul_f32 v3, 0x3ae38e39, v3
    v_fma_f32 v3, -v2, v2, v3
    v_cvt_pk_bf16_f32 v2, 0, v2
    v_max_f32 v3, 0, v3
    v_cvt_pk_bf16_f32 v3, 0, v3
    v_sub_f32 v212, v212, v2
    v_add_f32 v3, 0x3727c5ac, v3
    v_sub_f32 v213, v213, v2
    v_cvt_pk_bf16_f32 v3, 0, v3
    v_sub_f32 v214, v214, v2
    v_sqrt_f32 v3, v3
    v_sub_f32 v215, v215, v2
    v_cvt_pk_bf16_f32 v212, 0, v212
    v_cvt_pk_bf16_f32 v3, 0, v3
    v_cvt_pk_bf16_f32 v213, 0, v213
    v_rcp_f32 v3, v3
    v_cvt_pk_bf16_f32 v214, 0, v214
    v_cvt_pk_bf16_f32 v215, 0, v215
    v_mul_f32 v212, v212, v3
    v_mul_f32 v213, v213, v3
    v_mul_f32 v214, v214, v3
    v_mul_f32 v215, v215, v3
    v_cvt_pk_bf16_f32 v212, 0, v212
    v_cvt_pk_bf16_f32 v213, 0, v213
    v_cvt_pk_bf16_f32 v214, 0, v214
    v_cvt_pk_bf16_f32 v215, 0, v215
    s_mov_b32 s88, 81920
L_wperm:
    s_waitcnt vmcnt(0)
    v_perm_b32 v116, v134, v132, s82
    v_perm_b32 v117, v138, v136, s82
    v_perm_b32 v118, v142, v140, s82
    v_perm_b32 v119, v146, v144, s82
    v_perm_b32 v120, v134, v132, s83
    v_perm_b32 v121, v138, v136, s83
    v_perm_b32 v122, v142, v140, s83
    v_perm_b32 v123, v146, v144, s83
    v_perm_b32 v124, v135, v133, s82
    v_perm_b32 v125, v139, v137, s82
    v_perm_b32 v126, v143, v141, s82
    v_perm_b32 v127, v147, v145, s82
    v_perm_b32 v128, v135, v133, s83
    v_perm_b32 v129, v139, v137, s83
    v_perm_b32 v130, v143, v141, s83
    v_perm_b32 v131, v147, v145, s83
    v_perm_b32 v132, v150, v148, s82
    v_perm_b32 v133, v154, v152, s82
    v_perm_b32 v134, v158, v156, s82
    v_perm_b32 v135, v162, v160, s82
    v_perm_b32 v136, v150, v148, s83
    v_perm_b32 v137, v154, v152, s83
    v_perm_b32 v138, v158, v156, s83
    v_perm_b32 v139, v162, v160, s83
    v_perm_b32 v140, v151, v149, s82
    v_perm_b32 v141, v155, v153, s82
    v_perm_b32 v142, v159, v157, s82
    v_perm_b32 v143, v163, v161, s82
    v_perm_b32 v144, v151, v149, s83
    v_perm_b32 v145, v155, v153, s83
    v_perm_b32 v146, v159, v157, s83
    v_perm_b32 v147, v163, v161, s83
    v_perm_b32 v148, v166, v164, s82
    v_perm_b32 v149, v170, v168, s82
    v_perm_b32 v150, v174, v172, s82
    v_perm_b32 v151, v178, v176, s82
    v_perm_b32 v152, v166, v164, s83
    v_perm_b32 v153, v170, v168, s83
    v_perm_b32 v154, v174, v172, s83
    v_perm_b32 v155, v178, v176, s83
    v_perm_b32 v156, v167, v165, s82
    v_perm_b32 v157, v171, v169, s82
    v_perm_b32 v158, v175, v173, s82
    v_perm_b32 v159, v179, v177, s82
    v_perm_b32 v160, v167, v165, s83
    v_perm_b32 v161, v171, v169, s83
    v_perm_b32 v162, v175, v173, s83
    v_perm_b32 v163, v179, v177, s83
    v_perm_b32 v164, v182, v180, s82
    v_perm_b32 v165, v186, v184, s82
    v_perm_b32 v166, v190, v188, s82
    v_perm_b32 v167, v194, v192, s82
    v_perm_b32 v168, v182, v180, s83
    v_perm_b32 v169, v186, v184, s83
    v_perm_b32 v170, v190, v188, s83
    v_perm_b32 v171, v194, v192, s83
    v_perm_b32 v172, v183, v181, s82
    v_perm_b32 v173, v187, v185, s82
    v_perm_b32 v174, v191, v189, s82
    v_perm_b32 v175, v195, v193, s82
    v_perm_b32 v176, v183, v181, s83
    v_perm_b32 v177, v187, v185, s83
    v_perm_b32 v178, v191, v189, s83
    v_perm_b32 v179, v195, v193, s83
    v_perm_b32 v180, v198, v196, s82
    v_perm_b32 v181, v202, v200, s82
    v_perm_b32 v182, v198, v196, s83
    v_perm_b32 v183, v202, v200, s83
    v_perm_b32 v184, v199, v197, s82
    v_perm_b32 v185, v203, v201, s82
    v_perm_b32 v186, v199, v197, s83
    v_perm_b32 v187, v203, v201, s83
    s_cmp_eq_u32 s89, 1
    s_cbranch_scc1 L_gemv_run
    s_mov_b64 exec, s[84:85]
    v_mov_b32 v1, 0
L_wl_34:
    s_sleep 4
    ds_read_b32 v2, v1 offset:60
    s_waitcnt lgkmcnt(0)
    v_cmp_gt_u32 vcc, 5, v2
    s_cbranch_vccnz L_wl_34
    s_getreg_b32 s4, hwreg(HW_REG_XCC_ID, 0, 4)
    s_mul_i32 s4, s4, 0x1400
    s_and_b32 s5, s2, 7
    s_lshl_b32 s5, s5, 8
    s_add_u32 s4, s4, s5
    s_add_u32 s4, s4, 655360
    s_lshl_b32 s6, s35, 10
    s_movk_i32 s7, 0x400
    v_and_b32 v12, 31, v0
    v_lshlrev_b32 v12, 2, v12
    buffer_load_dword v12, v12, s[40:43], s4 offen sc1
    s_mul_i32 s86, s29, 576
    s_add_u32 s86, s86, 40960
    v_add_u32 v1, s86, v14
    v_add_u32 v3, 4608, v1
L_moda:
    buffer_load_dwordx4 v[16:19], v1, s[40:43], 0 offen offset:0 sc1
    buffer_load_dwordx4 v[20:23], v3, s[40:43], 0 offen offset:0 sc1
    buffer_load_dwordx4 v[24:27], v1, s[40:43], 0 offen offset:2304 sc1
    buffer_load_dwordx4 v[28:31], v3, s[40:43], 0 offen offset:2304 sc1
    buffer_load_dwordx4 v[32:35], v1, s[40:43], s58 offen offset:0 sc1
    buffer_load_dwordx4 v[36:39], v3, s[40:43], s58 offen offset:0 sc1
    buffer_load_dwordx4 v[40:43], v1, s[40:43], s58 offen offset:2304 sc1
    buffer_load_dwordx4 v[44:47], v3, s[40:43], s58 offen offset:2304 sc1
    s_waitcnt vmcnt(0)
    v_xor_b32 v2, s35, v17
    v_bitop3_b32 v2, v2, s35, v19 bitop3:0xf6
    v_bitop3_b32 v2, v2, s35, v21 bitop3:0xf6
    v_bitop3_b32 v2, v2, s35, v23 bitop3:0xf6
    v_bitop3_b32 v2, v2, s35, v25 bitop3:0xf6
    v_bitop3_b32 v2, v2, s35, v27 bitop3:0xf6
    v_bitop3_b32 v2, v2, s35, v29 bitop3:0xf6
    v_bitop3_b32 v2, v2, s35, v31 bitop3:0xf6
    v_bitop3_b32 v2, v2, s35, v33 bitop3:0xf6
    v_bitop3_b32 v2, v2, s35, v35 bitop3:0xf6
    v_bitop3_b32 v2, v2, s35, v37 bitop3:0xf6
    v_bitop3_b32 v2, v2, s35, v39 bitop3:0xf6
    v_bitop3_b32 v2, v2, s35, v41 bitop3:0xf6
    v_bitop3_b32 v2, v2, s35, v43 bitop3:0xf6
    v_bitop3_b32 v2, v2, s35, v45 bitop3:0xf6
    v_bitop3_b32 v2, v2, s35, v47 bitop3:0xf6
    v_cmp_ne_u32 vcc, 0, v2
    s_cbranch_vccz L_modad
    s_sleep 12
    s_add_u32 s81, s81, 1
    s_cmp_lt_u32 s81, 1048576
    s_cbranch_scc1 L_moda
L_modad:
    v_add_f32 v228, v16, v32
    v_add_f32 v229, v18, v34
    v_add_f32 v230, v20, v36
    v_add_f32 v231, v22, v38
    v_add_f32 v232, v24, v40
    v_add_f32 v233, v26, v42
    v_add_f32 v234, v28, v44
    v_add_f32 v235, v30, v46
    v_cvt_pk_bf16_f32 v228, 0, v228
    v_cvt_pk_bf16_f32 v229, 0, v229
    v_cvt_pk_bf16_f32 v230, 0, v230
    v_cvt_pk_bf16_f32 v231, 0, v231
    v_cvt_pk_bf16_f32 v232, 0, v232
    v_cvt_pk_bf16_f32 v233, 0, v233
    v_cvt_pk_bf16_f32 v234, 0, v234
    v_cvt_pk_bf16_f32 v235, 0, v235
    v_add_f32 v232, 1.0, v232
    v_add_f32 v233, 1.0, v233
    v_add_f32 v234, 1.0, v234
    v_add_f32 v235, 1.0, v235
    v_cvt_pk_bf16_f32 v232, 0, v232
    v_cvt_pk_bf16_f32 v233, 0, v233
    v_cvt_pk_bf16_f32 v234, 0, v234
    v_cvt_pk_bf16_f32 v235, 0, v235
    s_waitcnt vmcnt(0)
    v_xor_b32 v12, s6, v12
    v_cmp_le_u32 vcc, s7, v12
    s_nop 0
    s_cmp_eq_u64 vcc, 0
    s_cselect_b32 s89, 4, 0
    v_mul_f32 v212, v212, v232
    v_mul_f32 v213, v213, v233
    v_mul_f32 v214, v214, v234
    v_mul_f32 v215, v215, v235
    v_cvt_pk_bf16_f32 v212, 0, v212
    v_cvt_pk_bf16_f32 v213, 0, v213
    v_cvt_pk_bf16_f32 v214, 0, v214
    v_cvt_pk_bf16_f32 v215, 0, v215
    v_add_f32 v212, v212, v228
    v_add_f32 v213, v213, v229
    v_add_f32 v214, v214, v230
    v_add_f32 v215, v215, v231
    v_cvt_pk_bf16_f32 v2, v212, v213
    v_cvt_pk_bf16_f32 v3, v214, v215
    ds_write_b64 v246, v[2:3]
L_gemv_run:
    s_mov_b64 exec, -1
    ds_read_b64 v[80:81], v247 offset:64
    ds_read2_b64 v[64:67], v247 offset0:0 offset1:1
    ds_read2_b64 v[68:71], v247 offset0:2 offset1:3
    ds_read2_b64 v[72:75], v247 offset0:4 offset1:5
    ds_read2_b64 v[76:79], v247 offset0:6 offset1:7
    s_waitcnt lgkmcnt(4)
    v_mfma_f32_16x16x16_bf16 v[100:103], v[80:81], v[180:181], 0
    v_mfma_f32_16x16x16_bf16 v[104:107], v[80:81], v[182:183], 0
    v_mfma_f32_16x16x16_bf16 v[108:111], v[80:81], v[184:185], 0
    v_mfma_f32_16x16x16_bf16 v[112:115], v[80:81], v[186:187], 0
    s_waitcnt lgkmcnt(3)
    v_mfma_f32_16x16x32_bf16 v[84:87], v[64:67], v[116:119], 0
    v_mfma_f32_16x16x32_bf16 v[88:91], v[64:67], v[120:123], 0
    v_mfma_f32_16x16x32_bf16 v[92:95], v[64:67], v[124:127], 0
    v_mfma_f32_16x16x32_bf16 v[96:99], v[64:67], v[128:131], 0
    s_waitcnt lgkmcnt(2)
    v_mfma_f32_16x16x32_bf16 v[84:87], v[68:71], v[132:135], v[84:87]
    v_mfma_f32_16x16x32_bf16 v[88:91], v[68:71], v[136:139], v[88:91]
    v_mfma_f32_16x16x32_bf16 v[92:95], v[68:71], v[140:143], v[92:95]
    v_mfma_f32_16x16x32_bf16 v[96:99], v[68:71], v[144:147], v[96:99]
    s_waitcnt lgkmcnt(1)
    v_mfma_f32_16x16x32_bf16 v[84:87], v[72:75], v[148:151], v[84:87]
    v_mfma_f32_16x16x32_bf16 v[88:91], v[72:75], v[152:155], v[88:91]
    v_mfma_f32_16x16x32_bf16 v[92:95], v[72:75], v[156:159], v[92:95]
    v_mfma_f32_16x16x32_bf16 v[96:99], v[72:75], v[160:163], v[96:99]
    s_waitcnt lgkmcnt(0)
    v_mfma_f32_16x16x32_bf16 v[84:87], v[76:79], v[164:167], v[84:87]
    v_mfma_f32_16x16x32_bf16 v[88:91], v[76:79], v[168:171], v[88:91]
    v_mfma_f32_16x16x32_bf16 v[92:95], v[76:79], v[172:175], v[92:95]
    v_mfma_f32_16x16x32_bf16 v[96:99], v[76:79], v[176:179], v[96:99]
    s_nop 4
    v_add_f32 v4, v84, v100
    v_add_f32 v5, v88, v104
    v_add_f32 v6, v92, v108
    v_add_f32 v7, v96, v112
    s_mov_b64 exec, 0xffff
    ds_write_b128 v248, v[4:7] offset:2560
    s_mov_b64 exec, 1
    v_mov_b32 v1, 0
    v_mov_b32 v2, 1
    ds_add_rtn_u32 v2, v1, v2 offset:0
    s_mov_b64 exec, 0xffff
    ds_read_b128 v[4:7], v14 offset:2560
    ds_read_b128 v[8:11], v14 offset:2816
    s_lshl_b32 s86, s80, 8
    s_add_u32 s88, s88, s86
    s_mul_i32 s86, s31, 16384
    s_add_u32 s88, s88, s86
    s_waitcnt lgkmcnt(0)
    v_readfirstlane_b32 s86, v2
    v_add_f32 v4, v4, v8
    v_add_f32 v5, v5, v9
    v_add_f32 v6, v6, v10
    v_add_f32 v7, v7, v11
    s_cmp_lg_u32 s86, 1
    s_cbranch_scc1 L_pro_done
    s_cmp_lt_u32 s80, 18
    s_cselect_b32 s86, s89, 0
    s_cmp_eq_u32 s86, 1
    s_cbranch_scc0 L_pub_nib
    s_add_u32 s88, s88, 36864
    s_add_u32 s86, s88, 4608
    v_mov_b32 v8, v6
    v_mov_b32 v9, s35
    v_mov_b32 v10, v7
    v_mov_b32 v11, s35
    v_mov_b32 v6, v5
    v_mov_b32 v5, s35
    v_mov_b32 v7, s35
    buffer_store_dwordx4 v[4:7], v14, s[40:43], s88 offen sc1
    buffer_store_dwordx4 v[8:11], v14, s[40:43], s86 offen sc1
    s_branch L_pro_done
L_pub_nib:
    v_add_u32 v4, 8, v4
    v_add_u32 v5, 8, v5
    v_add_u32 v6, 8, v6
    v_add_u32 v7, 8, v7
    v_and_or_b32 v4, v4, -16, s24
    v_and_or_b32 v5, v5, -16, s25
    v_and_or_b32 v6, v6, -16, s26
    v_and_or_b32 v7, v7, -16, s27
    s_cmp_eq_u32 s89, 4
    s_cbranch_scc0 L_pub_far
    buffer_store_dwordx4 v[4:7], v14, s[40:43], s88 offen
    s_branch L_pro_done
L_pub_far:
    buffer_store_dwordx4 v[4:7], v14, s[40:43], s88 offen sc1
    s_branch L_pro_done
L_norole:
    s_waitcnt lgkmcnt(0)
    s_add_u32 s96, s35, 0x7f4a7c15
    s_mul_i32 s96, s96, 0x9e3779b1
    s_lshr_b32 s97, s96, 15
    s_xor_b32 s96, s96, s97
    s_mul_i32 s96, s96, 0x85ebca77
    s_lshr_b32 s97, s96, 13
    s_xor_b32 s96, s96, s97
    s_mul_i32 s96, s96, 0xc2b2ae3d
    s_lshr_b32 s97, s96, 16
    s_xor_b32 s96, s96, s97
    s_or_b32 s96, s96, 0x01010101
    s_xor_b32 s35, s35, s96
    s_and_b32 s96, s35, 0xff
    s_bfe_u32 s97, s35, 0x80008
    s_bfe_u32 s98, s35, 0x80010
    s_lshr_b32 s99, s35, 24
    s_and_b32 s24, s96, 15
    s_and_b32 s25, s97, 15
    s_and_b32 s26, s98, 15
    s_and_b32 s27, s99, 15
    s_cmp_lg_u32 s33, 3
    s_cbranch_scc1 L_pro_done
    s_getreg_b32 s4, hwreg(HW_REG_XCC_ID, 0, 4)
    s_mul_i32 s4, s4, 0x1400
    s_and_b32 s5, s2, 7
    s_lshl_b32 s5, s5, 8
    s_add_u32 s4, s4, s5
    s_add_u32 s4, s4, 655360
    s_lshl_b32 s6, s35, 10
    s_movk_i32 s7, 0x400
    s_lshr_b32 s5, s2, 3
    s_lshl2_add_u32 s5, s5, s4
    v_mov_b32 v1, 0
    v_mov_b32 v2, s6
    s_mov_b64 exec, 1
    buffer_store_dword v2, v1, s[40:43], s5 offen
L_pro_done:
    s_mov_b64 exec, -1
    s_cmp_lg_u32 s33, 2
    s_cbranch_scc1 L_q_done
    v_mov_b32 v1, 0
L_wl_35:
    s_sleep 4
    ds_read_b32 v2, v1 offset:60
    s_waitcnt lgkmcnt(0)
    v_cmp_gt_u32 vcc, 8, v2
    s_cbranch_vccnz L_wl_35
    s_and_b32 s86, s2, 8
    s_lshl_b32 s86, s86, 7
    s_and_b32 s87, s2, 7
    s_lshl_b32 s87, s87, 11
    s_or_b32 s86, s86, s87
    s_add_u32 s86, s86, 81920
    v_add_u32 v1, s86, v14
L_pt_36:
    buffer_load_dwordx4 v[4:7], v1, s[40:43], 0 offen sc1 nt
    buffer_load_dwordx4 v[8:11], v1, s[40:43], s58 offen sc1 nt
    s_waitcnt vmcnt(0)
    v_xor_b32 v4, s24, v4
    v_xor_b32 v5, s25, v5
    v_xor_b32 v6, s26, v6
    v_xor_b32 v7, s27, v7
    v_xor_b32 v8, s24, v8
    v_xor_b32 v9, s25, v9
    v_xor_b32 v10, s26, v10
    v_xor_b32 v11, s27, v11
    v_or_b32 v2, v4, v5
    v_or3_b32 v2, v2, v6, v7
    v_or3_b32 v2, v2, v8, v9
    v_or3_b32 v2, v2, v10, v11
    v_and_b32 v2, 15, v2
    v_cmp_ne_u32 vcc, 0, v2
    s_cbranch_vccz L_ptd_37
    s_sleep 12
    s_add_u32 s81, s81, 1
    s_cmp_lt_u32 s81, 1048576
    s_cbranch_scc1 L_pt_36
L_ptd_37:
    v_add_f32 v4, v4, v8
    v_add_f32 v5, v5, v9
    v_add_f32 v6, v6, v10
    v_add_f32 v7, v7, v11
    v_lshlrev_b32 v1, 3, v0
    v_cvt_pk_bf16_f32 v4, v4, v5
    v_cvt_pk_bf16_f32 v5, v6, v7
    ds_write_b64 v1, v[4:5] offset:256
    v_mov_b32 v1, 0
    v_mov_b32 v2, 1
    ds_write_b32 v1, v2 offset:224
L_q_done:
    v_mov_b32 v1, 0
L_wl_38:
    s_sleep 8
    ds_read_b32 v2, v1 offset:224
    s_waitcnt lgkmcnt(0)
    v_cmp_gt_u32 vcc, 1, v2
    s_cbranch_vccnz L_wl_38
    v_mov_b32 v249, 0xffffff00
    s_mov_b32 s44, s56
    s_mov_b32 s45, s57
    s_mul_i32 s86, s33, 192
    v_add_u32 v1, s86, v0
    v_lshlrev_b32 v253, 2, v1
    v_lshlrev_b32 v2, 1, v1
    s_getreg_b32 s4, hwreg(HW_REG_XCC_ID, 0, 4)
    s_and_b32 s87, s4, 3
    s_mul_i32 s87, s87, 18432
    s_mul_i32 s86, s33, 6144
    s_add_u32 s86, s86, s87
    s_add_u32 s86, s86, 753664
    v_add_u32 v252, s86, v14
    v_lshl_add_u32 v254, v245, 8, s86
    v_mov_b32 v250, 0
    v_mov_b32 v251, 0
    s_mov_b32 s22, 4096
    s_mul_i32 s4, s4, 0x1400
    s_add_u32 s4, s4, 655360
    s_and_b32 s86, s2, 7
    s_lshl_b32 s86, s86, 8
    s_add_u32 s4, s4, s86
    s_lshl_b32 s6, s35, 10
    s_movk_i32 s7, 0x400
    s_and_b32 s86, s2, 7
    s_mul_i32 s86, s86, 9
    s_lshr_b32 s80, s2, 3
    s_add_u32 s80, s80, s86
    s_cmp_lt_u32 s2, 144
    s_cselect_b32 s86, 9, 18
    s_sub_u32 s80, s80, s86
    s_sub_u32 s86, s2, 72
    s_cmp_ge_u32 s86, 72
    s_cbranch_scc1 L_prep_skip
    s_cmp_eq_u32 s33, 3
    s_cbranch_scc1 L_prep_w3
    buffer_load_ushort v236, v2, s[44:47], 0 offen offset:0
    buffer_load_ushort v237, v2, s[44:47], 0 offen offset:128
    buffer_load_ushort v238, v2, s[44:47], 0 offen offset:256
    v_add_u32 v1, 8704, v253
    v_and_b32 v3, 12, v253
    v_lshlrev_b32 v3, 1, v3
    v_bfe_u32 v3, s35, v3, 4
L_pt_39:
    buffer_load_dword v4, v1, s[40:43], 0 offen offset:0 sc1
    buffer_load_dword v5, v1, s[40:43], 0 offen offset:256 sc1
    buffer_load_dword v6, v1, s[40:43], 0 offen offset:512 sc1
    buffer_load_dword v7, v1, s[40:43], s58 offen offset:0 sc1
    buffer_load_dword v8, v1, s[40:43], s58 offen offset:256 sc1
    buffer_load_dword v9, v1, s[40:43], s58 offen offset:512 sc1
    s_waitcnt vmcnt(0)
    v_xor_b32 v4, v3, v4
    v_xor_b32 v5, v3, v5
    v_xor_b32 v6, v3, v6
    v_xor_b32 v7, v3, v7
    v_xor_b32 v8, v3, v8
    v_xor_b32 v9, v3, v9
    v_or_b32 v2, v4, v5
    v_or3_b32 v2, v2, v6, v7
    v_or3_b32 v2, v2, v8, v9
    v_and_b32 v2, 15, v2
    v_cmp_ne_u32 vcc, 0, v2
    s_cbranch_vccz L_ptd_40
    s_sleep 12
    s_add_u32 s81, s81, 1
    s_cmp_lt_u32 s81, 1048576
    s_cbranch_scc1 L_pt_39
L_ptd_40:
    v_add_f32 v240, v4, v7
    v_add_f32 v241, v5, v8
    v_add_f32 v242, v6, v9
    v_cvt_pk_bf16_f32 v240, 0, v240
    v_cvt_pk_bf16_f32 v241, 0, v241
    v_cvt_pk_bf16_f32 v242, 0, v242
    v_add_u32 v1, 11008, v253
    v_and_b32 v3, 12, v253
    v_lshlrev_b32 v3, 1, v3
    v_bfe_u32 v3, s35, v3, 4
L_pt_41:
    buffer_load_dword v4, v1, s[40:43], 0 offen offset:0 sc1
    buffer_load_dword v5, v1, s[40:43], 0 offen offset:256 sc1
    buffer_load_dword v6, v1, s[40:43], 0 offen offset:512 sc1
    buffer_load_dword v7, v1, s[40:43], s58 offen offset:0 sc1
    buffer_load_dword v8, v1, s[40:43], s58 offen offset:256 sc1
    buffer_load_dword v9, v1, s[40:43], s58 offen offset:512 sc1
    s_waitcnt vmcnt(0)
    v_xor_b32 v4, v3, v4
    v_xor_b32 v5, v3, v5
    v_xor_b32 v6, v3, v6
    v_xor_b32 v7, v3, v7
    v_xor_b32 v8, v3, v8
    v_xor_b32 v9, v3, v9
    v_or_b32 v2, v4, v5
    v_or3_b32 v2, v2, v6, v7
    v_or3_b32 v2, v2, v8, v9
    v_and_b32 v2, 15, v2
    v_cmp_ne_u32 vcc, 0, v2
    s_cbranch_vccz L_ptd_42
    s_sleep 12
    s_add_u32 s81, s81, 1
    s_cmp_lt_u32 s81, 1048576
    s_cbranch_scc1 L_pt_41
L_ptd_42:
    v_add_f32 v228, v4, v7
    v_add_f32 v229, v5, v8
    v_add_f32 v230, v6, v9
    v_cvt_pk_bf16_f32 v228, 0, v228
    v_cvt_pk_bf16_f32 v229, 0, v229
    v_cvt_pk_bf16_f32 v230, 0, v230
    v_add_u32 v1, 13312, v253
    v_and_b32 v3, 12, v253
    v_lshlrev_b32 v3, 1, v3
    v_bfe_u32 v3, s35, v3, 4
L_pt_43:
    buffer_load_dword v4, v1, s[40:43], 0 offen offset:0 sc1
    buffer_load_dword v5, v1, s[40:43], 0 offen offset:256 sc1
    buffer_load_dword v6, v1, s[40:43], 0 offen offset:512 sc1
    buffer_load_dword v7, v1, s[40:43], s58 offen offset:0 sc1
    buffer_load_dword v8, v1, s[40:43], s58 offen offset:256 sc1
    buffer_load_dword v9, v1, s[40:43], s58 offen offset:512 sc1
    s_waitcnt vmcnt(0)
    v_xor_b32 v4, v3, v4
    v_xor_b32 v5, v3, v5
    v_xor_b32 v6, v3, v6
    v_xor_b32 v7, v3, v7
    v_xor_b32 v8, v3, v8
    v_xor_b32 v9, v3, v9
    v_or_b32 v2, v4, v5
    v_or3_b32 v2, v2, v6, v7
    v_or3_b32 v2, v2, v8, v9
    v_and_b32 v2, 15, v2
    v_cmp_ne_u32 vcc, 0, v2
    s_cbranch_vccz L_ptd_44
    s_sleep 12
    s_add_u32 s81, s81, 1
    s_cmp_lt_u32 s81, 1048576
    s_cbranch_scc1 L_pt_43
L_ptd_44:
    v_add_f32 v232, v4, v7
    v_add_f32 v233, v5, v8
    v_add_f32 v234, v6, v9
    v_cvt_pk_bf16_f32 v232, 0, v232
    v_cvt_pk_bf16_f32 v233, 0, v233
    v_cvt_pk_bf16_f32 v234, 0, v234
    s_waitcnt vmcnt(0)
    v_lshlrev_b32 v236, 16, v236
    v_lshlrev_b32 v237, 16, v237
    v_lshlrev_b32 v238, 16, v238
    v_add_f32 v232, 1.0, v232
    v_add_f32 v233, 1.0, v233
    v_add_f32 v234, 1.0, v234
    v_cvt_pk_bf16_f32 v232, 0, v232
    v_cvt_pk_bf16_f32 v233, 0, v233
    v_cvt_pk_bf16_f32 v234, 0, v234
    s_branch L_prep_skip
L_prep_w3:
    s_lshr_b32 s86, s80, 3
    s_lshl_b32 s86, s86, 6
    s_and_b32 s87, s80, 7
    s_lshl_b32 s87, s87, 1
    s_add_u32 s86, s86, s87
    v_and_b32 v3, 1, v0
    v_lshl_add_u32 v1, v244, 4, v3
    v_add_u32 v1, s86, v1
    v_lshlrev_b32 v253, 2, v1
    v_lshrrev_b32 v2, 1, v0
    v_mul_u32_u24 v2, 2304, v2
    v_lshl_add_u32 v2, v3, 4, v2
    s_lshl_b32 s86, s80, 5
    s_add_u32 s86, s86, 393216
    v_add_u32 v252, s86, v2
    s_mov_b32 s22, 55296
    s_mov_b32 s23, 110592
    v_add_u32 v1, 15616, v253
L_prep_skip:
    v_mov_b32 v1, 0
    s_cmp_eq_u32 s33, 0
    s_cbranch_scc1 L_control
    s_cmp_lg_u32 s33, 1
    s_cbranch_scc1 L_w23
L_wl_45:
    s_sleep 16
    ds_read_b32 v2, v1 offset:16
    s_waitcnt lgkmcnt(0)
    v_cmp_gt_u32 vcc, 4, v2
    s_cbranch_vccnz L_wl_45
    ds_read_b128 v[4:7], v1 offset:10240
    ds_read_b128 v[8:11], v1 offset:10256
    v_and_b32 v2, 31, v0
    v_lshlrev_b32 v2, 2, v2
    buffer_load_dword v3, v2, s[40:43], s4 offen sc1
    v_add_u32 v12, 12288, v14
    v_mov_b32 v22, 0
    v_mov_b32 v23, 0
    s_mov_b32 s86, 16
    s_waitcnt lgkmcnt(0)
    v_max3_f32 v20, v4, v6, v8
    v_max3_f32 v21, v5, v7, v9
    v_max_f32 v20, v20, v10
    v_max_f32 v21, v21, v11
L_lsum:
    ds_read_b128 v[4:7], v12
    v_add_u32 v12, 1024, v12
    s_waitcnt lgkmcnt(0)
    v_lshlrev_b32 v8, 16, v4
    v_lshlrev_b32 v9, 16, v5
    v_lshlrev_b32 v10, 16, v6
    v_lshlrev_b32 v11, 16, v7
    v_and_b32 v4, 0xffff0000, v4
    v_and_b32 v5, 0xffff0000, v5
    v_and_b32 v6, 0xffff0000, v6
    v_and_b32 v7, 0xffff0000, v7
    v_sub_f32 v8, v8, v20
    v_sub_f32 v9, v9, v20
    v_sub_f32 v10, v10, v20
    v_sub_f32 v11, v11, v20
    v_sub_f32 v4, v4, v21
    v_sub_f32 v5, v5, v21
    v_sub_f32 v6, v6, v21
    v_sub_f32 v7, v7, v21
    v_mul_f32 v4, s19, v4
    v_mul_f32 v5, s19, v5
    v_mul_f32 v6, s19, v6
    v_mul_f32 v7, s19, v7
    v_mul_f32 v8, s19, v8
    v_mul_f32 v9, s19, v9
    v_mul_f32 v10, s19, v10
    v_mul_f32 v11, s19, v11
    v_exp_f32 v4, v4
    v_exp_f32 v5, v5
    v_exp_f32 v6, v6
    v_exp_f32 v7, v7
    v_exp_f32 v8, v8
    v_exp_f32 v9, v9
    v_exp_f32 v10, v10
    v_exp_f32 v11, v11
    v_add_f32 v23, v23, v4
    v_add_f32 v23, v23, v5
    v_add_f32 v23, v23, v6
    v_add_f32 v23, v23, v7
    v_add_f32 v22, v22, v8
    v_add_f32 v22, v22, v9
    v_add_f32 v22, v22, v10
    v_add_f32 v22, v22, v11
    s_sub_u32 s86, s86, 1
    s_cmp_lg_u32 s86, 0
    s_cbranch_scc1 L_lsum
    v_add_f32_dpp v22, v22, v22 quad_perm:[1,0,3,2] row_mask:0xf bank_mask:0xf
    v_add_f32_dpp v23, v23, v23 quad_perm:[1,0,3,2] row_mask:0xf bank_mask:0xf
    s_nop 0
    v_add_f32_dpp v22, v22, v22 quad_perm:[2,3,0,1] row_mask:0xf bank_mask:0xf
    v_add_f32_dpp v23, v23, v23 quad_perm:[2,3,0,1] row_mask:0xf bank_mask:0xf
    s_nop 0
    v_add_f32_dpp v22, v22, v22 row_ror:4 row_mask:0xf bank_mask:0xf
    v_add_f32_dpp v23, v23, v23 row_ror:4 row_mask:0xf bank_mask:0xf
    s_nop 0
    v_add_f32_dpp v22, v22, v22 row_ror:8 row_mask:0xf bank_mask:0xf
    v_add_f32_dpp v23, v23, v23 row_ror:8 row_mask:0xf bank_mask:0xf
    v_mov_b32 v4, v22
    v_mov_b32 v5, v23
    s_nop 0
    v_permlane16_swap_b32 v22, v4
    v_permlane16_swap_b32 v23, v5
    v_add_f32 v22, v22, v4
    v_add_f32 v23, v23, v5
    v_mov_b32 v4, v22
    v_mov_b32 v5, v23
    s_nop 0
    v_permlane32_swap_b32 v22, v4
    v_permlane32_swap_b32 v23, v5
    v_add_f32 v22, v22, v4
    v_add_f32 v23, v23, v5
    s_waitcnt vmcnt(0)
    v_xor_b32 v3, s6, v3
    v_cmp_le_u32 vcc, s7, v3
    s_lshl_b32 s86, s34, 4
    s_add_u32 s86, s86, 36864
    s_cmp_eq_u64 vcc, 0
    s_cselect_b32 s5, 2, 1
    v_and_or_b32 v20, v20, v249, s96
    v_and_or_b32 v21, v21, v249, s97
    v_and_or_b32 v22, v22, v249, s98
    v_and_or_b32 v23, v23, v249, s99
    s_mov_b64 exec, 1
    s_cmp_eq_u32 s5, 2
    s_cbranch_scc0 L_stfar
    buffer_store_dwordx4 v[20:23], v1, s[40:43], s86 offen
    s_branch L_stdone
L_stfar:
    buffer_store_dwordx4 v[20:23], v1, s[40:43], s86 offen sc1
L_stdone:
    s_mov_b64 exec, -1
L_wl_46:
    s_sleep 16
    ds_read_b32 v2, v1 offset:4
    s_waitcnt lgkmcnt(0)
    v_cmp_gt_u32 vcc, 712, v2
    s_cbranch_vccnz L_wl_46
    s_and_b32 s86, s86, 0xffffff00
    v_lshl_add_u32 v3, v245, 4, s86
    v_lshlrev_b32 v12, 3, v0
    ds_read_b64 v[10:11], v12 offset:10240
    s_mov_b32 s8, -1
    s_mov_b32 s9, -1
L_pm_47:
    s_mov_b64 exec, s[8:9]
    s_cbranch_execz L_sk_50
    buffer_load_dwordx4 v[20:23], v3, s[40:43], 0 offen sc1
L_sk_50:
L_pmc_49:
    s_waitcnt vmcnt(0)
    v_xor_b32 v20, s96, v20
    v_xor_b32 v21, s97, v21
    v_xor_b32 v22, s98, v22
    v_xor_b32 v23, s99, v23
    v_or3_b32 v2, v20, v21, v22
    v_bitop3_b32 v2, v2, v23, v249 bitop3:0x54
    v_cmp_ne_u32 s[8:9], 0, v2
    s_nop 0
    s_wqm_b64 s[8:9], s[8:9]
    s_cbranch_scc0 L_pmd_48
    s_sleep 16
    s_add_u32 s81, s81, 1
    s_cmp_lt_u32 s81, 1048576
    s_cbranch_scc1 L_pm_47
L_pmd_48:
    s_mov_b64 exec, -1
    v_mov_b32 v4, v20
    v_mov_b32 v5, v21
    s_nop 0
    v_max_f32_dpp v4, v4, v4 quad_perm:[1,0,3,2] row_mask:0xf bank_mask:0xf
    v_max_f32_dpp v5, v5, v5 quad_perm:[1,0,3,2] row_mask:0xf bank_mask:0xf
    s_nop 0
    v_max_f32_dpp v4, v4, v4 quad_perm:[2,3,0,1] row_mask:0xf bank_mask:0xf
    v_max_f32_dpp v5, v5, v5 quad_perm:[2,3,0,1] row_mask:0xf bank_mask:0xf
    s_nop 0
    v_max_f32_dpp v4, v4, v4 row_ror:4 row_mask:0xf bank_mask:0xf
    v_max_f32_dpp v5, v5, v5 row_ror:4 row_mask:0xf bank_mask:0xf
    s_nop 0
    v_max_f32_dpp v4, v4, v4 row_ror:8 row_mask:0xf bank_mask:0xf
    v_max_f32_dpp v5, v5, v5 row_ror:8 row_mask:0xf bank_mask:0xf
    v_sub_f32 v20, v20, v4
    v_sub_f32 v21, v21, v5
    s_waitcnt lgkmcnt(0)
    v_sub_f32 v10, v10, v4
    v_sub_f32 v11, v11, v5
    v_mul_f32 v20, s19, v20
    v_mul_f32 v21, s19, v21
    v_mul_f32 v10, s19, v10
    v_mul_f32 v11, s19, v11
    v_exp_f32 v20, v20
    v_exp_f32 v21, v21
    v_exp_f32 v10, v10
    v_exp_f32 v11, v11
    v_mul_f32 v22, v22, v20
    v_mul_f32 v23, v23, v21
    s_nop 0
    v_add_f32_dpp v22, v22, v22 quad_perm:[1,0,3,2] row_mask:0xf bank_mask:0xf
    v_add_f32_dpp v23, v23, v23 quad_perm:[1,0,3,2] row_mask:0xf bank_mask:0xf
    s_nop 0
    v_add_f32_dpp v22, v22, v22 quad_perm:[2,3,0,1] row_mask:0xf bank_mask:0xf
    v_add_f32_dpp v23, v23, v23 quad_perm:[2,3,0,1] row_mask:0xf bank_mask:0xf
    s_nop 0
    v_add_f32_dpp v22, v22, v22 row_ror:4 row_mask:0xf bank_mask:0xf
    v_add_f32_dpp v23, v23, v23 row_ror:4 row_mask:0xf bank_mask:0xf
    s_nop 0
    v_add_f32_dpp v22, v22, v22 row_ror:8 row_mask:0xf bank_mask:0xf
    v_add_f32_dpp v23, v23, v23 row_ror:8 row_mask:0xf bank_mask:0xf
    v_rcp_f32 v22, v22
    v_rcp_f32 v23, v23
    v_mul_f32 v10, v10, v22
    v_mul_f32 v11, v11, v23
    v_mov_b32 v2, s5
    s_mov_b64 exec, 15
    ds_write_b64 v12, v[10:11] offset:192
    s_mov_b64 exec, 1
    ds_write_b32 v1, v2 offset:28
    s_mov_b64 exec, -1
    s_branch L_wait_ticket
L_w23:
    s_cmp_lg_u32 s33, 2
    s_cbranch_scc1 L_wait_ticket
    s_cmp_lt_u32 s2, 248
    s_cbranch_scc1 L_wait_ticket
    v_and_b32 v10, 3, v0
    v_lshlrev_b32 v10, 2, v10
    s_mov_b32 s13, 32
    s_mov_b32 s16, 917504
    s_mov_b32 s12, 0
L_mile:
    s_sleep 1
    ds_read_b32 v4, v1 offset:24
    ds_read_b32 v9, v10 offset:240
    s_waitcnt lgkmcnt(0)
    v_add_u32_dpp v2, v9, v9 quad_perm:[1,0,3,2] row_mask:0xf bank_mask:0xf
    s_nop 1
    v_add_u32_dpp v2, v2, v2 quad_perm:[2,3,0,1] row_mask:0xf bank_mask:0xf
    s_nop 0
    v_readfirstlane_b32 s8, v2
    v_add_u32 v4, v4, v2
    s_cmp_ge_u32 s8, 832
    s_cbranch_scc1 L_wait_ticket
    v_cmp_gt_i32 vcc, s13, v4
    s_cbranch_vccnz L_mile
    v_mov_b32 v4, 1
    s_mov_b64 exec, 1
    buffer_atomic_add v4, v1, s[40:43], s16 offen sc0
    s_mul_i32 s12, s12, 2
    s_ashr_i32 s12, s12, 2
    s_add_u32 s16, s16, 0x1100
    s_add_u32 s13, s13, 48
    s_waitcnt vmcnt(0)
    v_readfirstlane_b32 s9, v4
    s_nop 0
    s_and_b32 s9, s9, 7
    s_lshl_b32 s9, s9, 1
    s_sub_i32 s9, s9, 7
    s_mul_i32 s9, s9, 2
    s_ashr_i32 s9, s9, 2
    s_add_i32 s12, s12, s9
    s_add_i32 s17, s12, 64
    s_or_b32 s17, s17, s6
    v_mov_b32 v4, s17
    buffer_store_dword v4, v1, s[40:43], s4 offen offset:128
    s_mov_b64 exec, -1
    s_cmp_le_u32 s13, 752
    s_cbranch_scc1 L_mile
    s_branch L_wait_ticket
L_control:
    v_and_b32 v10, 3, v0
    v_lshlrev_b32 v10, 2, v10
    v_min_u32 v11, 32, v0
    v_lshlrev_b32 v11, 2, v11
    s_lshr_b32 s5, s2, 3
    s_lshl2_add_u32 s5, s5, s4
    s_and_b32 s20, s80, 7
    s_cmp_eq_u32 s20, 3
    s_cselect_b32 s10, 10, 0
    s_cmp_lt_u32 s2, 144
    s_cselect_b32 s10, s10, 0
    s_cmp_lt_u32 s2, 72
    s_cselect_b32 s10, 10, s10
L_ctl:
    ds_read_b32 v9, v10 offset:240
    s_waitcnt lgkmcnt(0)
    v_add_u32_dpp v2, v9, v9 quad_perm:[1,0,3,2] row_mask:0xf bank_mask:0xf
    s_nop 1
    v_add_u32_dpp v2, v2, v2 quad_perm:[2,3,0,1] row_mask:0xf bank_mask:0xf
    s_nop 0
    v_readfirstlane_b32 s8, v2
    ds_write_b32 v1, v2 offset:4
    s_cmp_ge_u32 s8, 808
    s_cbranch_scc1 L_ctl_fin
    s_min_u32 s9, s8, s10
    s_sub_i32 s8, s8, s9
    s_add_i32 s9, s9, 5
    s_or_b32 s14, s6, s8
    v_mov_b32 v2, s14
    s_mov_b64 exec, 1
    buffer_store_dword v2, v1, s[40:43], s5 offen
    s_mov_b64 exec, -1
    buffer_load_dword v8, v11, s[40:43], s4 offen sc1
    v_lshlrev_b32 v9, 2, v9
    v_sub_u32 v9, s9, v9
    s_waitcnt vmcnt(0)
    v_xor_b32 v8, s6, v8
    v_cmp_gt_u32 vcc, s7, v8
    s_nop 1
    v_cndmask_b32 v3, 0, v8, vcc
    v_cndmask_b32 v8, 64, v8, vcc
    s_bcnt1_i32_b32 s14, vcc_lo
    s_max_u32 s14, s14, 1
    v_cvt_f32_u32 v4, s14
    v_rcp_f32 v4, v4
    v_readlane_b32 s14, v8, 32
    v_add_u32_dpp v3, v3, v3 quad_perm:[1,0,3,2] row_mask:0xf bank_mask:0xf
    s_nop 1
    v_add_u32_dpp v3, v3, v3 quad_perm:[2,3,0,1] row_mask:0xf bank_mask:0xf
    s_nop 1
    v_add_u32_dpp v3, v3, v3 row_ror:4 row_mask:0xf bank_mask:0xf
    s_nop 1
    v_add_u32_dpp v3, v3, v3 row_ror:8 row_mask:0xf bank_mask:0xf
    s_nop 0
    v_readlane_b32 s15, v3, 0
    v_readlane_b32 s17, v3, 16
    s_sub_i32 s14, s14, 64
    s_add_u32 s15, s15, s17
    v_cvt_f32_u32 v3, s15
    v_fma_f32 v3, v3, v4, 0.5
    v_cvt_u32_f32 v3, v3
    v_subrev_u32 v4, s8, v3
    ds_write_b32 v1, v4 offset:24
    v_add_u32 v3, s14, v3
    v_add_u32 v3, v9, v3
    ds_write_b32 v10, v3 offset:32
    s_sleep 8
    s_branch L_ctl
L_ctl_fin:
    s_or_b32 s8, s6, 832
    v_mov_b32 v2, s8
    s_mov_b64 exec, 1
    buffer_store_dword v2, v1, s[40:43], s5 offen
    s_mov_b64 exec, -1
    v_mov_b32 v2, 1
    ds_write_b32 v1, v2 offset:8
    s_mov_b64 exec, -1
    s_branch L_go
L_wait_ticket:
L_wl_51:
    s_sleep 3
    ds_read_b32 v2, v1 offset:8
    s_waitcnt lgkmcnt(0)
    v_cmp_gt_u32 vcc, 1, v2
    s_cbranch_vccnz L_wl_51
L_go:
    s_cmp_ge_u32 s2, 216
    s_cbranch_scc1 L_g_role
    s_cmp_ge_u32 s2, 144
    s_cbranch_scc1 L_b_role
    s_cmp_ge_u32 s2, 72
    s_cbranch_scc1 L_a_role
    s_and_b32 s29, s2, 7
    s_lshr_b32 s32, s2, 3
    s_mov_b32 s36, s62
    s_mov_b32 s37, s63
    s_mov_b32 s38, 4718592
    v_bfe_u32 v3, v0, 3, 2
    v_lshrrev_b32 v2, 5, v0
    v_lshl_add_u32 v3, v3, 3, v2
    v_mul_u32_u24 v3, 1152, v3
    s_and_b32 s86, s2, 7
    s_lshl_b32 s86, s86, 9
    s_lshl_b32 s87, s33, 1
    s_add_u32 s86, s86, s87
    s_mul_i32 s86, s86, 1152
    s_lshl_b32 s79, s32, 7
    s_add_u32 s79, s79, s86
    s_lshl_b32 s87, s33, 14
    s_add_u32 s87, s87, 28672
    v_lshrrev_b32 v4, 4, v0
    v_lshlrev_b32 v4, 1, v4
    v_xor_b32 v4, v4, v0
    v_and_b32 v4, 7, v4
    v_lshlrev_b32 v2, 4, v4
    v_add_u32 v3, v3, v2
    v_and_b32 v10, 3, v0
    v_lshlrev_b32 v10, 2, v10
L_wp_52:
    s_sleep 1
    ds_read_b32 v9, v10 offset:240
    s_waitcnt lgkmcnt(0)
    v_add_u32_dpp v2, v9, v9 quad_perm:[1,0,3,2] row_mask:0xf bank_mask:0xf
    s_nop 1
    v_add_u32_dpp v2, v2, v2 quad_perm:[2,3,0,1] row_mask:0xf bank_mask:0xf
    s_nop 0
    v_readfirstlane_b32 s8, v2
    s_nop 0
    s_cmp_lt_u32 s8, 832
    s_cbranch_scc1 L_wp_52
    s_add_u32 m0, s87, 0
    s_add_u32 s86, s79, 0
    buffer_load_dwordx4 v3, s[36:39], s86 offen nt lds
    s_add_u32 m0, s87, 1024
    s_add_u32 s86, s79, 147456
    buffer_load_dwordx4 v3, s[36:39], s86 offen nt lds
    s_add_u32 m0, s87, 2048
    s_add_u32 s86, s79, 36864
    buffer_load_dwordx4 v3, s[36:39], s86 offen nt lds
    s_add_u32 m0, s87, 3072
    s_add_u32 s86, s79, 184320
    buffer_load_dwordx4 v3, s[36:39], s86 offen nt lds
    s_add_u32 m0, s87, 4096
    s_add_u32 s86, s79, 73728
    buffer_load_dwordx4 v3, s[36:39], s86 offen nt lds
    s_add_u32 m0, s87, 5120
    s_add_u32 s86, s79, 221184
    buffer_load_dwordx4 v3, s[36:39], s86 offen nt lds
    s_add_u32 m0, s87, 6144
    s_add_u32 s86, s79, 110592
    buffer_load_dwordx4 v3, s[36:39], s86 offen nt lds
L_wl_53:
    s_sleep 1
    ds_read_b32 v2, v1 offset:236
    s_waitcnt lgkmcnt(0)
    v_cmp_gt_u32 vcc, 1, v2
    s_cbranch_vccnz L_wl_53
    s_add_u32 m0, s87, 7168
    s_add_u32 s86, s79, 258048
    buffer_load_dwordx4 v3, s[36:39], s86 offen nt lds
    s_add_u32 m0, s87, 8192
    s_add_u32 s86, s79, 294912
    buffer_load_dwordx4 v3, s[36:39], s86 offen nt lds
    s_add_u32 m0, s87, 9216
    s_add_u32 s86, s79, 442368
    buffer_load_dwordx4 v3, s[36:39], s86 offen nt lds
    s_add_u32 m0, s87, 10240
    s_add_u32 s86, s79, 331776
    buffer_load_dwordx4 v3, s[36:39], s86 offen nt lds
    s_add_u32 m0, s87, 11264
    s_add_u32 s86, s79, 479232
    buffer_load_dwordx4 v3, s[36:39], s86 offen nt lds
    s_add_u32 m0, s87, 12288
    s_add_u32 s86, s79, 368640
    buffer_load_dwordx4 v3, s[36:39], s86 offen nt lds
    s_add_u32 m0, s87, 13312
    s_add_u32 s86, s79, 516096
    buffer_load_dwordx4 v3, s[36:39], s86 offen nt lds
    s_add_u32 m0, s87, 14336
    s_add_u32 s86, s79, 405504
    buffer_load_dwordx4 v3, s[36:39], s86 offen nt lds
    s_add_u32 m0, s87, 15360
    s_add_u32 s86, s79, 552960
    buffer_load_dwordx4 v3, s[36:39], s86 offen nt lds
    v_lshrrev_b32 v2, 2, v0
    v_and_b32 v3, 3, v0
    v_lshl_add_u32 v3, v3, 3, s87
    v_lshl_add_u32 v3, v2, 7, v3
    v_bfe_u32 v2, v2, 1, 2
    v_xor_b32 v4, 0, v2
    v_xor_b32 v5, 1, v2
    v_xor_b32 v6, 2, v2
    v_xor_b32 v7, 3, v2
    v_lshl_add_u32 v4, v4, 5, v3
    v_lshl_add_u32 v5, v5, 5, v3
    v_lshl_add_u32 v6, v6, 5, v3
    v_lshl_add_u32 v7, v7, 5, v3
    s_lshl_b32 s26, s2, 8
    s_add_u32 s26, s26, 753664
    s_lshl_b32 s86, s29, 15
    s_lshl_b32 s87, s33, 8
    s_add_u32 s86, s86, s87
    s_add_u32 s86, s86, 131072
    v_lshlrev_b32 v251, 4, v245
    v_lshl_add_u32 v1, v244, 12, v251
    v_add_u32 v250, s86, v1
    v_mul_u32_u24 v1, 18432, v244
    v_add_u32 v252, v1, v251
    s_mul_i32 s86, s33, 320
    s_add_u32 s86, s86, 768
    s_movk_i32 s22, 0x4000
    v_mov_b32 v10, 0
    v_mov_b32 v11, 1
    v_and_b32 v8, 7, v0
    v_lshl_add_u32 v8, v244, 3, v8
    v_and_b32 v9, 8, v0
    v_lshl_add_u32 v8, v9, 2, v8
    v_and_b32 v9, 49, v8
    v_and_b32 v12, 12, v8
    v_lshl_add_u32 v12, v9, 1, v12
    v_and_b32 v9, 2, v8
    v_lshl_add_u32 v12, v9, 3, v12
    v_and_b32 v255, 1, v0
    v_lshrrev_b32 v13, 4, v0
    v_lshlrev_b32 v13, 5, v13
    v_lshl_add_u32 v13, v255, 4, v13
    v_mul_u32_u24 v255, 0xaaaa, v255
    v_add_u32 v255, 0x4444, v255
    v_mov_b32 v84, 0
    v_mov_b32 v85, 0
    v_mov_b32 v86, 0
    v_mov_b32 v87, 0
    v_mov_b32 v88, 0
    v_mov_b32 v89, 0
    v_mov_b32 v90, 0
    v_mov_b32 v91, 0
    v_mov_b32 v92, 0
    v_mov_b32 v93, 0
    v_mov_b32 v94, 0
    v_mov_b32 v95, 0
    v_mov_b32 v96, 0
    v_mov_b32 v97, 0
    v_mov_b32 v98, 0
    v_mov_b32 v99, 0
    v_add_u32 v12, s86, v12
    v_add_u32 v13, s86, v13
    s_mov_b32 s4, -1
    s_mov_b32 s5, -1
    s_mov_b32 s6, -1
    s_mov_b32 s7, -1
    s_mov_b32 s8, -1
    s_mov_b32 s9, -1
    s_mov_b32 s10, -1
    s_mov_b32 s11, -1
    buffer_load_dwordx4 v[16:19], v250, s[40:43], 0 offen offset:0 sc1 nt
    buffer_load_dwordx4 v[32:35], v250, s[40:43], s22 offen offset:0 sc1 nt
    buffer_load_dwordx4 v[20:23], v250, s[40:43], 0 offen offset:1024 sc1 nt
    buffer_load_dwordx4 v[36:39], v250, s[40:43], s22 offen offset:1024 sc1 nt
    buffer_load_dwordx4 v[24:27], v250, s[40:43], 0 offen offset:2048 sc1 nt
    buffer_load_dwordx4 v[40:43], v250, s[40:43], s22 offen offset:2048 sc1 nt
    buffer_load_dwordx4 v[28:31], v250, s[40:43], 0 offen offset:3072 sc1 nt
    buffer_load_dwordx4 v[44:47], v250, s[40:43], s22 offen offset:3072 sc1 nt
    s_waitcnt vmcnt(20) lgkmcnt(4)
    ds_read_b64_tr_b16 v[116:117], v4 offset:0
    ds_read_b64_tr_b16 v[118:119], v4 offset:2048
    ds_read_b64_tr_b16 v[124:125], v5 offset:0
    ds_read_b64_tr_b16 v[126:127], v5 offset:2048
    ds_read_b64_tr_b16 v[132:133], v6 offset:0
    ds_read_b64_tr_b16 v[134:135], v6 offset:2048
    ds_read_b64_tr_b16 v[140:141], v7 offset:0
    ds_read_b64_tr_b16 v[142:143], v7 offset:2048
    s_waitcnt vmcnt(16) lgkmcnt(4)
    ds_read_b64_tr_b16 v[120:121], v4 offset:4096
    ds_read_b64_tr_b16 v[122:123], v4 offset:6144
    ds_read_b64_tr_b16 v[128:129], v5 offset:4096
    ds_read_b64_tr_b16 v[130:131], v5 offset:6144
    ds_read_b64_tr_b16 v[136:137], v6 offset:4096
    ds_read_b64_tr_b16 v[138:139], v6 offset:6144
    ds_read_b64_tr_b16 v[144:145], v7 offset:4096
    ds_read_b64_tr_b16 v[146:147], v7 offset:6144
    s_waitcnt vmcnt(12) lgkmcnt(4)
    ds_read_b64_tr_b16 v[148:149], v4 offset:8192
    ds_read_b64_tr_b16 v[150:151], v4 offset:10240
    ds_read_b64_tr_b16 v[156:157], v5 offset:8192
    ds_read_b64_tr_b16 v[158:159], v5 offset:10240
    ds_read_b64_tr_b16 v[164:165], v6 offset:8192
    ds_read_b64_tr_b16 v[166:167], v6 offset:10240
    ds_read_b64_tr_b16 v[172:173], v7 offset:8192
    ds_read_b64_tr_b16 v[174:175], v7 offset:10240
    s_waitcnt vmcnt(8) lgkmcnt(4)
    ds_read_b64_tr_b16 v[152:153], v4 offset:12288
    ds_read_b64_tr_b16 v[154:155], v4 offset:14336
    ds_read_b64_tr_b16 v[160:161], v5 offset:12288
    ds_read_b64_tr_b16 v[162:163], v5 offset:14336
    ds_read_b64_tr_b16 v[168:169], v6 offset:12288
    ds_read_b64_tr_b16 v[170:171], v6 offset:14336
    ds_read_b64_tr_b16 v[176:177], v7 offset:12288
    ds_read_b64_tr_b16 v[178:179], v7 offset:14336
    s_branch L_pmc_56
L_pm_54:
    s_mov_b64 exec, s[4:5]
    s_cbranch_execz L_sk_57
    buffer_load_dwordx4 v[16:19], v250, s[40:43], 0 offen offset:0 sc1
    buffer_load_dwordx4 v[32:35], v250, s[40:43], s22 offen offset:0 sc1
L_sk_57:
    s_mov_b64 exec, s[6:7]
    s_cbranch_execz L_sk_58
    buffer_load_dwordx4 v[20:23], v250, s[40:43], 0 offen offset:1024 sc1
    buffer_load_dwordx4 v[36:39], v250, s[40:43], s22 offen offset:1024 sc1
L_sk_58:
    s_mov_b64 exec, s[8:9]
    s_cbranch_execz L_sk_59
    buffer_load_dwordx4 v[24:27], v250, s[40:43], 0 offen offset:2048 sc1
    buffer_load_dwordx4 v[40:43], v250, s[40:43], s22 offen offset:2048 sc1
L_sk_59:
    s_mov_b64 exec, s[10:11]
    s_cbranch_execz L_sk_60
    buffer_load_dwordx4 v[28:31], v250, s[40:43], 0 offen offset:3072 sc1
    buffer_load_dwordx4 v[44:47], v250, s[40:43], s22 offen offset:3072 sc1
L_sk_60:
L_pmc_56:
    s_mov_b32 s86, 0
    s_waitcnt vmcnt(0)
    s_mov_b64 exec, s[4:5]
    s_cbranch_execz L_sk_61
    v_xor_b32 v16, s96, v16
    v_xor_b32 v17, s97, v17
    v_xor_b32 v18, s98, v18
    v_xor_b32 v19, s99, v19
    v_or3_b32 v2, v16, v17, v18
    v_xor_b32 v32, s96, v32
    v_xor_b32 v33, s97, v33
    v_xor_b32 v34, s98, v34
    v_xor_b32 v35, s99, v35
    v_or3_b32 v2, v2, v32, v33
    v_or3_b32 v2, v2, v34, v35
    v_bitop3_b32 v2, v2, v19, v249 bitop3:0x54
    v_cmp_ne_u32 s[4:5], 0, v2
    s_nop 0
    s_wqm_b64 s[4:5], s[4:5]
    s_addc_u32 s86, s86, 0
L_sk_61:
    s_mov_b64 exec, s[6:7]
    s_cbranch_execz L_sk_62
    v_xor_b32 v20, s96, v20
    v_xor_b32 v21, s97, v21
    v_xor_b32 v22, s98, v22
    v_xor_b32 v23, s99, v23
    v_or3_b32 v2, v20, v21, v22
    v_xor_b32 v36, s96, v36
    v_xor_b32 v37, s97, v37
    v_xor_b32 v38, s98, v38
    v_xor_b32 v39, s99, v39
    v_or3_b32 v2, v2, v36, v37
    v_or3_b32 v2, v2, v38, v39
    v_bitop3_b32 v2, v2, v23, v249 bitop3:0x54
    v_cmp_ne_u32 s[6:7], 0, v2
    s_nop 0
    s_wqm_b64 s[6:7], s[6:7]
    s_addc_u32 s86, s86, 0
L_sk_62:
    s_mov_b64 exec, s[8:9]
    s_cbranch_execz L_sk_63
    v_xor_b32 v24, s96, v24
    v_xor_b32 v25, s97, v25
    v_xor_b32 v26, s98, v26
    v_xor_b32 v27, s99, v27
    v_or3_b32 v2, v24, v25, v26
    v_xor_b32 v40, s96, v40
    v_xor_b32 v41, s97, v41
    v_xor_b32 v42, s98, v42
    v_xor_b32 v43, s99, v43
    v_or3_b32 v2, v2, v40, v41
    v_or3_b32 v2, v2, v42, v43
    v_bitop3_b32 v2, v2, v27, v249 bitop3:0x54
    v_cmp_ne_u32 s[8:9], 0, v2
    s_nop 0
    s_wqm_b64 s[8:9], s[8:9]
    s_addc_u32 s86, s86, 0
L_sk_63:
    s_mov_b64 exec, s[10:11]
    s_cbranch_execz L_sk_64
    v_xor_b32 v28, s96, v28
    v_xor_b32 v29, s97, v29
    v_xor_b32 v30, s98, v30
    v_xor_b32 v31, s99, v31
    v_or3_b32 v2, v28, v29, v30
    v_xor_b32 v44, s96, v44
    v_xor_b32 v45, s97, v45
    v_xor_b32 v46, s98, v46
    v_xor_b32 v47, s99, v47
    v_or3_b32 v2, v2, v44, v45
    v_or3_b32 v2, v2, v46, v47
    v_bitop3_b32 v2, v2, v31, v249 bitop3:0x54
    v_cmp_ne_u32 s[10:11], 0, v2
    s_nop 0
    s_wqm_b64 s[10:11], s[10:11]
    s_addc_u32 s86, s86, 0
L_sk_64:
    s_cmp_eq_u32 s86, 0
    s_cbranch_scc1 L_pmd_55
    s_cmp_eq_u32 s86, 1
    s_cbranch_scc1 L_one_65
    s_add_u32 s81, s81, 1
    s_cmp_lt_u32 s81, 1048576
    s_cbranch_scc1 L_pm_54
    s_branch L_pmd_55
L_one_65:
L_ag_67:
    s_mov_b64 exec, s[4:5]
    s_cbranch_execz L_nx_66
    buffer_load_dwordx4 v[16:19], v250, s[40:43], 0 offen offset:0 sc1
    buffer_load_dwordx4 v[32:35], v250, s[40:43], s22 offen offset:0 sc1
    s_add_u32 s81, s81, 1
    s_cmp_ge_u32 s81, 1048576
    s_cbranch_scc1 L_pmd_55
    s_waitcnt vmcnt(1)
    v_xor_b32 v16, s96, v16
    v_xor_b32 v17, s97, v17
    v_xor_b32 v18, s98, v18
    v_xor_b32 v19, s99, v19
    v_or3_b32 v2, v16, v17, v18
    s_waitcnt vmcnt(0)
    v_xor_b32 v32, s96, v32
    v_xor_b32 v33, s97, v33
    v_xor_b32 v34, s98, v34
    v_xor_b32 v35, s99, v35
    v_or3_b32 v2, v2, v32, v33
    v_or3_b32 v2, v2, v34, v35
    v_bitop3_b32 v2, v2, v19, v249 bitop3:0x54
    v_cmp_ne_u32 s[4:5], 0, v2
    s_nop 0
    s_wqm_b64 s[4:5], s[4:5]
    s_cbranch_scc1 L_ag_67
    s_branch L_pmd_55
L_nx_66:
L_ag_69:
    s_mov_b64 exec, s[6:7]
    s_cbranch_execz L_nx_68
    buffer_load_dwordx4 v[20:23], v250, s[40:43], 0 offen offset:1024 sc1
    buffer_load_dwordx4 v[36:39], v250, s[40:43], s22 offen offset:1024 sc1
    s_add_u32 s81, s81, 1
    s_cmp_ge_u32 s81, 1048576
    s_cbranch_scc1 L_pmd_55
    s_waitcnt vmcnt(1)
    v_xor_b32 v20, s96, v20
    v_xor_b32 v21, s97, v21
    v_xor_b32 v22, s98, v22
    v_xor_b32 v23, s99, v23
    v_or3_b32 v2, v20, v21, v22
    s_waitcnt vmcnt(0)
    v_xor_b32 v36, s96, v36
    v_xor_b32 v37, s97, v37
    v_xor_b32 v38, s98, v38
    v_xor_b32 v39, s99, v39
    v_or3_b32 v2, v2, v36, v37
    v_or3_b32 v2, v2, v38, v39
    v_bitop3_b32 v2, v2, v23, v249 bitop3:0x54
    v_cmp_ne_u32 s[6:7], 0, v2
    s_nop 0
    s_wqm_b64 s[6:7], s[6:7]
    s_cbranch_scc1 L_ag_69
    s_branch L_pmd_55
L_nx_68:
L_ag_71:
    s_mov_b64 exec, s[8:9]
    s_cbranch_execz L_nx_70
    buffer_load_dwordx4 v[24:27], v250, s[40:43], 0 offen offset:2048 sc1
    buffer_load_dwordx4 v[40:43], v250, s[40:43], s22 offen offset:2048 sc1
    s_add_u32 s81, s81, 1
    s_cmp_ge_u32 s81, 1048576
    s_cbranch_scc1 L_pmd_55
    s_waitcnt vmcnt(1)
    v_xor_b32 v24, s96, v24
    v_xor_b32 v25, s97, v25
    v_xor_b32 v26, s98, v26
    v_xor_b32 v27, s99, v27
    v_or3_b32 v2, v24, v25, v26
    s_waitcnt vmcnt(0)
    v_xor_b32 v40, s96, v40
    v_xor_b32 v41, s97, v41
    v_xor_b32 v42, s98, v42
    v_xor_b32 v43, s99, v43
    v_or3_b32 v2, v2, v40, v41
    v_or3_b32 v2, v2, v42, v43
    v_bitop3_b32 v2, v2, v27, v249 bitop3:0x54
    v_cmp_ne_u32 s[8:9], 0, v2
    s_nop 0
    s_wqm_b64 s[8:9], s[8:9]
    s_cbranch_scc1 L_ag_71
    s_branch L_pmd_55
L_nx_70:
L_ag_73:
    s_mov_b64 exec, s[10:11]
    s_cbranch_execz L_nx_72
    buffer_load_dwordx4 v[28:31], v250, s[40:43], 0 offen offset:3072 sc1
    buffer_load_dwordx4 v[44:47], v250, s[40:43], s22 offen offset:3072 sc1
    s_add_u32 s81, s81, 1
    s_cmp_ge_u32 s81, 1048576
    s_cbranch_scc1 L_pmd_55
    s_waitcnt vmcnt(1)
    v_xor_b32 v28, s96, v28
    v_xor_b32 v29, s97, v29
    v_xor_b32 v30, s98, v30
    v_xor_b32 v31, s99, v31
    v_or3_b32 v2, v28, v29, v30
    s_waitcnt vmcnt(0)
    v_xor_b32 v44, s96, v44
    v_xor_b32 v45, s97, v45
    v_xor_b32 v46, s98, v46
    v_xor_b32 v47, s99, v47
    v_or3_b32 v2, v2, v44, v45
    v_or3_b32 v2, v2, v46, v47
    v_bitop3_b32 v2, v2, v31, v249 bitop3:0x54
    v_cmp_ne_u32 s[10:11], 0, v2
    s_nop 0
    s_wqm_b64 s[10:11], s[10:11]
    s_cbranch_scc1 L_ag_73
L_nx_72:
L_pmd_55:
    s_mov_b64 exec, -1
    v_pk_add_f32 v[16:17], v[16:17], v[20:21]
    v_pk_add_f32 v[18:19], v[18:19], v[22:23]
    v_pk_add_f32 v[32:33], v[32:33], v[36:37]
    v_pk_add_f32 v[34:35], v[34:35], v[38:39]
    v_pk_add_f32 v[24:25], v[24:25], v[28:29]
    v_pk_add_f32 v[26:27], v[26:27], v[30:31]
    v_pk_add_f32 v[40:41], v[40:41], v[44:45]
    v_pk_add_f32 v[42:43], v[42:43], v[46:47]
    v_pk_add_f32 v[16:17], v[16:17], v[24:25]
    v_pk_add_f32 v[18:19], v[18:19], v[26:27]
    v_pk_add_f32 v[32:33], v[32:33], v[40:41]
    v_pk_add_f32 v[34:35], v[34:35], v[42:43]
    v_permlane32_swap_b32 v16, v18
    v_permlane32_swap_b32 v17, v19
    v_permlane32_swap_b32 v32, v34
    v_permlane32_swap_b32 v33, v35
    v_add_f32 v16, v16, v18
    v_add_f32 v17, v17, v19
    v_add_f32 v32, v32, v34
    v_add_f32 v33, v33, v35
    v_permlane16_swap_b32 v16, v17
    s_nop 0
    v_permlane16_swap_b32 v32, v33
    v_add_f32 v16, v16, v17
    v_add_f32 v32, v32, v33
    v_cvt_pk_bf16_f32 v8, v16, v32
    ds_write_b16 v12, v8
    ds_write_b16_d16_hi v12, v8 offset:128
    ds_read_b128 v[64:67], v13 offset:0
    ds_read_b128 v[68:71], v13 offset:128
    s_waitcnt lgkmcnt(1)
    v_smfmac_f32_16x16x64_bf16 v[84:87], v[64:67], v[116:123], v255
    v_smfmac_f32_16x16x64_bf16 v[88:91], v[64:67], v[124:131], v255
    v_smfmac_f32_16x16x64_bf16 v[92:95], v[64:67], v[132:139], v255
    v_smfmac_f32_16x16x64_bf16 v[96:99], v[64:67], v[140:147], v255
    s_waitcnt lgkmcnt(0)
    v_smfmac_f32_16x16x64_bf16 v[84:87], v[68:71], v[148:155], v255
    v_smfmac_f32_16x16x64_bf16 v[88:91], v[68:71], v[156:163], v255
    v_smfmac_f32_16x16x64_bf16 v[92:95], v[68:71], v[164:171], v255
    v_smfmac_f32_16x16x64_bf16 v[96:99], v[68:71], v[172:179], v255
    s_nop 4
    v_add_f32 v4, v84, v85
    v_add_f32 v5, v88, v89
    v_add_f32 v6, v92, v93
    v_add_f32 v7, v96, v97
    s_mov_b64 exec, 0xffff
    ds_write_b128 v248, v[4:7] offset:2560
    s_mov_b64 exec, 1
    ds_add_rtn_u32 v11, v10, v11 offset:20
    s_mov_b32 exec_lo, -1
    s_mov_b32 exec_hi, -1
    ds_read_b128 v[16:19], v251 offset:2560
    ds_read_b128 v[20:23], v251 offset:2816
    ds_read_b128 v[24:27], v251 offset:3072
    ds_read_b128 v[28:31], v251 offset:3328
    s_waitcnt lgkmcnt(2)
    v_readfirstlane_b32 s86, v11
    v_pk_add_f32 v[16:17], v[16:17], v[20:21]
    v_pk_add_f32 v[18:19], v[18:19], v[22:23]
    s_cmp_lg_u32 s86, 3
    s_cbranch_scc1 L_exit
    s_waitcnt lgkmcnt(0)
    v_pk_add_f32 v[24:25], v[24:25], v[28:29]
    v_pk_add_f32 v[26:27], v[26:27], v[30:31]
    v_pk_add_f32 v[16:17], v[16:17], v[24:25]
    v_pk_add_f32 v[18:19], v[18:19], v[26:27]
    v_and_or_b32 v16, v16, v249, s96
    v_and_or_b32 v17, v17, v249, s97
    v_and_or_b32 v18, v18, v249, s98
    v_and_or_b32 v19, v19, v249, s99
    buffer_store_dwordx4 v[16:19], v252, s[40:43], s26 offen sc1
    s_branch L_exit
L_g_role:
    s_cmp_ge_u32 s2, 234
    s_cbranch_scc1 L_exit
    s_cmp_ge_u32 s33, 2
    s_cbranch_scc1 L_exit
    s_sub_u32 s80, s2, 126
    s_and_b32 s31, s80, 1
    s_lshr_b32 s80, s80, 1
    s_lshl1_add_u32 s29, s31, s33
    s_mov_b32 s36, s70
    s_mov_b32 s37, s71
    s_mov_b32 s38, 3981312
    s_mov_b32 s44, s68
    s_mov_b32 s45, s69
    s_mul_i32 s86, s29, 288
    v_lshlrev_b32 v2, 3, v0
    s_mov_b64 exec, s[84:85]
    buffer_load_dwordx2 v[204:205], v2, s[44:47], s86 offen
    s_mov_b64 exec, -1
    v_lshl_add_u32 v12, s29, 2, v244
    v_mul_u32_u24 v12, 248832, v12
    v_lshl_add_u32 v12, v245, 3, v12
    s_lshl_b32 s79, s80, 7
    s_waitcnt vmcnt(0)
    v_lshlrev_b32 v212, 16, v204
    v_and_b32 v213, 0xffff0000, v204
    v_lshlrev_b32 v214, 16, v205
    v_and_b32 v215, 0xffff0000, v205
    s_mov_b64 exec, s[84:85]
    s_mov_b32 s86, 0x32a57060
    s_mov_b32 s87, 0x7f7fffff
    v_mul_f32 v4, 0xbfb8aa3b, v212
    v_mul_f32 v5, 0xbfb8aa3b, v213
    v_mul_f32 v6, 0xbfb8aa3b, v214
    v_mul_f32 v7, 0xbfb8aa3b, v215
    v_fma_f32 v8, -v212, s19, -v4
    v_fma_f32 v9, -v213, s19, -v5
    v_fma_f32 v10, -v214, s19, -v6
    v_fma_f32 v11, -v215, s19, -v7
    v_exp_f32 v4, v4
    v_exp_f32 v5, v5
    v_exp_f32 v6, v6
    v_exp_f32 v7, v7
    v_fma_f32 v8, -v212, s86, v8
    v_fma_f32 v9, -v213, s86, v9
    v_fma_f32 v10, -v214, s86, v10
    v_fma_f32 v11, -v215, s86, v11
    v_mul_f32 v8, 0x3f317218, v8
    v_mul_f32 v9, 0x3f317218, v9
    v_mul_f32 v10, 0x3f317218, v10
    v_mul_f32 v11, 0x3f317218, v11
    v_med3_f32 v8, v8, -0.5, 0.5
    v_med3_f32 v9, v9, -0.5, 0.5
    v_med3_f32 v10, v10, -0.5, 0.5
    v_med3_f32 v11, v11, -0.5, 0.5
    v_min_f32 v216, s87, v4
    v_min_f32 v217, s87, v5
    v_min_f32 v218, s87, v6
    v_min_f32 v219, s87, v7
    v_fma_f32 v4, v216, v8, v4
    v_fma_f32 v5, v217, v9, v5
    v_fma_f32 v6, v218, v10, v6
    v_fma_f32 v7, v219, v11, v7
    v_add_f32 v4, 1.0, v4
    v_add_f32 v5, 1.0, v5
    v_add_f32 v6, 1.0, v6
    v_add_f32 v7, 1.0, v7
    v_rcp_f32 v8, v4
    v_rcp_f32 v9, v5
    v_rcp_f32 v10, v6
    v_rcp_f32 v11, v7
    v_mul_f32 v216, v212, v8
    v_mul_f32 v217, v213, v9
    v_mul_f32 v218, v214, v10
    v_mul_f32 v219, v215, v11
    v_fma_f32 v220, -v216, v4, v212
    v_fma_f32 v221, -v217, v5, v213
    v_fma_f32 v222, -v218, v6, v214
    v_fma_f32 v223, -v219, v7, v215
    v_fma_f32 v216, v220, v8, v216
    v_fma_f32 v217, v221, v9, v217
    v_fma_f32 v218, v222, v10, v218
    v_fma_f32 v219, v223, v11, v219
    v_div_fixup_f32 v4, v216, v4, v212
    v_div_fixup_f32 v5, v217, v5, v213
    v_div_fixup_f32 v6, v218, v6, v214
    v_div_fixup_f32 v7, v219, v7, v215
    v_cvt_pk_bf16_f32 v2, v4, v5
    v_cvt_pk_bf16_f32 v3, v6, v7
    ds_write_b64 v246, v[2:3]
    s_mov_b64 exec, -1
L_wl_74:
    s_sleep 1
    ds_read_b32 v2, v1 offset:236
    s_waitcnt lgkmcnt(0)
    v_cmp_gt_u32 vcc, 1, v2
    s_cbranch_vccnz L_wl_74
    s_mov_b32 s20, s25
    s_and_b32 s25, s2, 7
    s_lshl_b32 s25, s25, 15
    s_add_u32 s25, s25, 131072
    v_lshlrev_b32 v8, 10, v0
    s_mov_b32 exec_hi, 0
    buffer_load_dwordx2 v[10:11], v8, s[40:43], s25 offen sc1 nt
L_cg_75:
    s_waitcnt vmcnt(0)
    v_xor_b32 v10, s96, v10
    v_xor_b32 v11, s97, v11
    v_bitop3_b32 v10, v10, v11, v249 bitop3:0x54
    v_cmp_ne_u32 vcc, 0, v10
    s_nop 0
    s_bcnt1_i32_b64 s86, vcc
    s_cmp_le_u32 s86, 4
    s_cbranch_scc1 L_cgd_76
    buffer_load_dwordx2 v[10:11], v8, s[40:43], s25 offen sc1
    s_add_u32 s81, s81, 1
    s_cmp_lt_u32 s81, 1048576
    s_cbranch_scc1 L_cg_75
    s_waitcnt vmcnt(0)
L_cgd_76:
    s_mov_b64 exec, -1
    s_mov_b32 s25, s20
    buffer_load_dwordx2 v[132:133], v12, s[36:39], s79 offen nt
    s_add_u32 s79, s79, 6912
    buffer_load_dwordx2 v[134:135], v12, s[36:39], s79 offen nt
    s_add_u32 s79, s79, 6912
    buffer_load_dwordx2 v[136:137], v12, s[36:39], s79 offen nt
    s_add_u32 s79, s79, 6912
    buffer_load_dwordx2 v[138:139], v12, s[36:39], s79 offen nt
    s_add_u32 s79, s79, 6912
    buffer_load_dwordx2 v[140:141], v12, s[36:39], s79 offen nt
    s_add_u32 s79, s79, 6912
    buffer_load_dwordx2 v[142:143], v12, s[36:39], s79 offen nt
    s_add_u32 s79, s79, 6912
    buffer_load_dwordx2 v[144:145], v12, s[36:39], s79 offen nt
    s_add_u32 s79, s79, 6912
    buffer_load_dwordx2 v[146:147], v12, s[36:39], s79 offen nt
    s_add_u32 s79, s79, 6912
    buffer_load_dwordx2 v[148:149], v12, s[36:39], s79 offen nt
    s_add_u32 s79, s79, 6912
    buffer_load_dwordx2 v[150:151], v12, s[36:39], s79 offen nt
    s_add_u32 s79, s79, 6912
    buffer_load_dwordx2 v[152:153], v12, s[36:39], s79 offen nt
    s_add_u32 s79, s79, 6912
    buffer_load_dwordx2 v[154:155], v12, s[36:39], s79 offen nt
    s_add_u32 s79, s79, 6912
    buffer_load_dwordx2 v[156:157], v12, s[36:39], s79 offen nt
    s_add_u32 s79, s79, 6912
    buffer_load_dwordx2 v[158:159], v12, s[36:39], s79 offen nt
    s_add_u32 s79, s79, 6912
    buffer_load_dwordx2 v[160:161], v12, s[36:39], s79 offen nt
    s_add_u32 s79, s79, 6912
    buffer_load_dwordx2 v[162:163], v12, s[36:39], s79 offen nt
    s_add_u32 s79, s79, 6912
    buffer_load_dwordx2 v[164:165], v12, s[36:39], s79 offen nt
    s_add_u32 s79, s79, 6912
    buffer_load_dwordx2 v[166:167], v12, s[36:39], s79 offen nt
    s_add_u32 s79, s79, 6912
    buffer_load_dwordx2 v[168:169], v12, s[36:39], s79 offen nt
    s_add_u32 s79, s79, 6912
    buffer_load_dwordx2 v[170:171], v12, s[36:39], s79 offen nt
    s_add_u32 s79, s79, 6912
    buffer_load_dwordx2 v[172:173], v12, s[36:39], s79 offen nt
    s_add_u32 s79, s79, 6912
    buffer_load_dwordx2 v[174:175], v12, s[36:39], s79 offen nt
    s_add_u32 s79, s79, 6912
    buffer_load_dwordx2 v[176:177], v12, s[36:39], s79 offen nt
    s_add_u32 s79, s79, 6912
    buffer_load_dwordx2 v[178:179], v12, s[36:39], s79 offen nt
    s_add_u32 s79, s79, 6912
    buffer_load_dwordx2 v[180:181], v12, s[36:39], s79 offen nt
    s_add_u32 s79, s79, 6912
    buffer_load_dwordx2 v[182:183], v12, s[36:39], s79 offen nt
    s_add_u32 s79, s79, 6912
    buffer_load_dwordx2 v[184:185], v12, s[36:39], s79 offen nt
    s_add_u32 s79, s79, 6912
    buffer_load_dwordx2 v[186:187], v12, s[36:39], s79 offen nt
    s_add_u32 s79, s79, 6912
    buffer_load_dwordx2 v[188:189], v12, s[36:39], s79 offen nt
    s_add_u32 s79, s79, 6912
    buffer_load_dwordx2 v[190:191], v12, s[36:39], s79 offen nt
    s_add_u32 s79, s79, 6912
    buffer_load_dwordx2 v[192:193], v12, s[36:39], s79 offen nt
    s_add_u32 s79, s79, 6912
    buffer_load_dwordx2 v[194:195], v12, s[36:39], s79 offen nt
    s_add_u32 s79, s79, 6912
    buffer_load_dwordx2 v[196:197], v12, s[36:39], s79 offen nt
    s_add_u32 s79, s79, 6912
    buffer_load_dwordx2 v[198:199], v12, s[36:39], s79 offen nt
    s_add_u32 s79, s79, 6912
    buffer_load_dwordx2 v[200:201], v12, s[36:39], s79 offen nt
    s_add_u32 s79, s79, 6912
    buffer_load_dwordx2 v[202:203], v12, s[36:39], s79 offen nt
    s_waitcnt vmcnt(0)
    v_perm_b32 v116, v134, v132, s82
    v_perm_b32 v117, v138, v136, s82
    v_perm_b32 v118, v142, v140, s82
    v_perm_b32 v119, v146, v144, s82
    v_perm_b32 v120, v134, v132, s83
    v_perm_b32 v121, v138, v136, s83
    v_perm_b32 v122, v142, v140, s83
    v_perm_b32 v123, v146, v144, s83
    v_perm_b32 v124, v135, v133, s82
    v_perm_b32 v125, v139, v137, s82
    v_perm_b32 v126, v143, v141, s82
    v_perm_b32 v127, v147, v145, s82
    v_perm_b32 v128, v135, v133, s83
    v_perm_b32 v129, v139, v137, s83
    v_perm_b32 v130, v143, v141, s83
    v_perm_b32 v131, v147, v145, s83
    v_perm_b32 v132, v150, v148, s82
    v_perm_b32 v133, v154, v152, s82
    v_perm_b32 v134, v158, v156, s82
    v_perm_b32 v135, v162, v160, s82
    v_perm_b32 v136, v150, v148, s83
    v_perm_b32 v137, v154, v152, s83
    v_perm_b32 v138, v158, v156, s83
    v_perm_b32 v139, v162, v160, s83
    v_perm_b32 v140, v151, v149, s82
    v_perm_b32 v141, v155, v153, s82
    v_perm_b32 v142, v159, v157, s82
    v_perm_b32 v143, v163, v161, s82
    v_perm_b32 v144, v151, v149, s83
    v_perm_b32 v145, v155, v153, s83
    v_perm_b32 v146, v159, v157, s83
    v_perm_b32 v147, v163, v161, s83
    v_perm_b32 v148, v166, v164, s82
    v_perm_b32 v149, v170, v168, s82
    v_perm_b32 v150, v174, v172, s82
    v_perm_b32 v151, v178, v176, s82
    v_perm_b32 v152, v166, v164, s83
    v_perm_b32 v153, v170, v168, s83
    v_perm_b32 v154, v174, v172, s83
    v_perm_b32 v155, v178, v176, s83
    v_perm_b32 v156, v167, v165, s82
    v_perm_b32 v157, v171, v169, s82
    v_perm_b32 v158, v175, v173, s82
    v_perm_b32 v159, v179, v177, s82
    v_perm_b32 v160, v167, v165, s83
    v_perm_b32 v161, v171, v169, s83
    v_perm_b32 v162, v175, v173, s83
    v_perm_b32 v163, v179, v177, s83
    v_perm_b32 v164, v182, v180, s82
    v_perm_b32 v165, v186, v184, s82
    v_perm_b32 v166, v190, v188, s82
    v_perm_b32 v167, v194, v192, s82
    v_perm_b32 v168, v182, v180, s83
    v_perm_b32 v169, v186, v184, s83
    v_perm_b32 v170, v190, v188, s83
    v_perm_b32 v171, v194, v192, s83
    v_perm_b32 v172, v183, v181, s82
    v_perm_b32 v173, v187, v185, s82
    v_perm_b32 v174, v191, v189, s82
    v_perm_b32 v175, v195, v193, s82
    v_perm_b32 v176, v183, v181, s83
    v_perm_b32 v177, v187, v185, s83
    v_perm_b32 v178, v191, v189, s83
    v_perm_b32 v179, v195, v193, s83
    v_perm_b32 v180, v198, v196, s82
    v_perm_b32 v181, v202, v200, s82
    v_perm_b32 v182, v198, v196, s83
    v_perm_b32 v183, v202, v200, s83
    v_perm_b32 v184, v199, v197, s82
    v_perm_b32 v185, v203, v201, s82
    v_perm_b32 v186, v199, v197, s83
    v_perm_b32 v187, v203, v201, s83
    s_mov_b64 exec, -1
    ds_read_b64 v[80:81], v247 offset:64
    ds_read2_b64 v[64:67], v247 offset0:0 offset1:1
    ds_read2_b64 v[68:71], v247 offset0:2 offset1:3
    ds_read2_b64 v[72:75], v247 offset0:4 offset1:5
    ds_read2_b64 v[76:79], v247 offset0:6 offset1:7
    s_waitcnt lgkmcnt(4)
    v_mfma_f32_16x16x16_bf16 v[100:103], v[80:81], v[180:181], 0
    v_mfma_f32_16x16x16_bf16 v[104:107], v[80:81], v[182:183], 0
    v_mfma_f32_16x16x16_bf16 v[108:111], v[80:81], v[184:185], 0
    v_mfma_f32_16x16x16_bf16 v[112:115], v[80:81], v[186:187], 0
    s_waitcnt lgkmcnt(3)
    v_mfma_f32_16x16x32_bf16 v[84:87], v[64:67], v[116:119], 0
    v_mfma_f32_16x16x32_bf16 v[88:91], v[64:67], v[120:123], 0
    v_mfma_f32_16x16x32_bf16 v[92:95], v[64:67], v[124:127], 0
    v_mfma_f32_16x16x32_bf16 v[96:99], v[64:67], v[128:131], 0
    s_waitcnt lgkmcnt(2)
    v_mfma_f32_16x16x32_bf16 v[84:87], v[68:71], v[132:135], v[84:87]
    v_mfma_f32_16x16x32_bf16 v[88:91], v[68:71], v[136:139], v[88:91]
    v_mfma_f32_16x16x32_bf16 v[92:95], v[68:71], v[140:143], v[92:95]
    v_mfma_f32_16x16x32_bf16 v[96:99], v[68:71], v[144:147], v[96:99]
    s_waitcnt lgkmcnt(1)
    v_mfma_f32_16x16x32_bf16 v[84:87], v[72:75], v[148:151], v[84:87]
    v_mfma_f32_16x16x32_bf16 v[88:91], v[72:75], v[152:155], v[88:91]
    v_mfma_f32_16x16x32_bf16 v[92:95], v[72:75], v[156:159], v[92:95]
    v_mfma_f32_16x16x32_bf16 v[96:99], v[72:75], v[160:163], v[96:99]
    s_waitcnt lgkmcnt(0)
    v_mfma_f32_16x16x32_bf16 v[84:87], v[76:79], v[164:167], v[84:87]
    v_mfma_f32_16x16x32_bf16 v[88:91], v[76:79], v[168:171], v[88:91]
    v_mfma_f32_16x16x32_bf16 v[92:95], v[76:79], v[172:175], v[92:95]
    v_mfma_f32_16x16x32_bf16 v[96:99], v[76:79], v[176:179], v[96:99]
    s_nop 4
    v_add_f32 v4, v84, v100
    v_add_f32 v5, v88, v104
    v_add_f32 v6, v92, v108
    v_add_f32 v7, v96, v112
    s_mov_b64 exec, 0xffff
    ds_write_b128 v248, v[4:7] offset:2560
    s_mov_b64 exec, 1
    v_mov_b32 v2, 1
    ds_add_rtn_u32 v2, v1, v2 offset:20
    s_mov_b64 exec, 0xffff
    ds_read_b128 v[4:7], v14 offset:2560
    ds_read_b128 v[8:11], v14 offset:2816
    s_lshl_b32 s88, s80, 8
    s_mul_i32 s86, s31, 16384
    s_add_u32 s88, s88, s86
    s_add_u32 s88, s88, 4096
    s_waitcnt lgkmcnt(0)
    v_readfirstlane_b32 s86, v2
    v_add_f32 v4, v4, v8
    v_add_f32 v5, v5, v9
    v_add_f32 v6, v6, v10
    v_add_f32 v7, v7, v11
    v_add_u32 v4, 8, v4
    v_add_u32 v5, 8, v5
    v_add_u32 v6, 8, v6
    v_add_u32 v7, 8, v7
    v_and_or_b32 v4, v4, -16, s24
    v_and_or_b32 v5, v5, -16, s25
    v_and_or_b32 v6, v6, -16, s26
    v_and_or_b32 v7, v7, -16, s27
    s_cmp_lg_u32 s86, 1
    s_cbranch_scc1 L_exit
    buffer_store_dwordx4 v[4:7], v14, s[40:43], s88 offen sc1
    s_branch L_exit
L_b_role:
    s_cmp_eq_u32 s33, 3
    s_cbranch_scc1 L_exit
    s_mov_b32 s36, s66
    s_mov_b32 s37, s67
    s_mov_b32 s38, 5308416
    s_mul_i32 s79, s80, 73728
    s_mul_i32 s86, s33, 384
    s_add_u32 s79, s79, s86
    v_bfe_u32 v3, v0, 3, 2
    v_lshrrev_b32 v2, 5, v0
    v_lshl_add_u32 v3, v2, 3, v3
    v_mul_u32_u24 v3, 1152, v3
    s_mul_i32 s87, s33, 24576
    s_add_u32 s87, s87, 28672
    v_lshrrev_b32 v4, 4, v0
    v_lshlrev_b32 v4, 1, v4
    v_xor_b32 v4, v4, v0
    v_and_b32 v4, 7, v4
    v_lshlrev_b32 v2, 4, v4
    v_add_u32 v3, v3, v2
L_wl_77:
    s_sleep 1
    ds_read_b32 v2, v1 offset:236
    s_waitcnt lgkmcnt(0)
    v_cmp_gt_u32 vcc, 1, v2
    s_cbranch_vccnz L_wl_77
    s_and_b32 s25, s2, 7
    s_lshl_b32 s25, s25, 15
    s_add_u32 s25, s25, 131072
    v_lshlrev_b32 v8, 10, v0
    s_mov_b32 exec_hi, 0
    buffer_load_dwordx2 v[10:11], v8, s[40:43], s25 offen sc1 nt
L_cg_78:
    s_waitcnt vmcnt(0)
    v_xor_b32 v10, s96, v10
    v_xor_b32 v11, s97, v11
    v_bitop3_b32 v10, v10, v11, v249 bitop3:0x54
    v_cmp_ne_u32 vcc, 0, v10
    s_nop 0
    s_bcnt1_i32_b64 s86, vcc
    s_cmp_le_u32 s86, 4
    s_cbranch_scc1 L_cgd_79
    buffer_load_dwordx2 v[10:11], v8, s[40:43], s25 offen sc1
    s_add_u32 s81, s81, 1
    s_cmp_lt_u32 s81, 1048576
    s_cbranch_scc1 L_cg_78
    s_waitcnt vmcnt(0)
L_cgd_79:
    s_mov_b64 exec, -1
    s_add_u32 m0, s87, 0
    s_add_u32 s86, s79, 0
    buffer_load_dwordx4 v3, s[36:39], s86 offen nt lds
    s_add_u32 m0, s87, 1024
    s_add_u32 s86, s79, 18432
    buffer_load_dwordx4 v3, s[36:39], s86 offen nt lds
    s_add_u32 m0, s87, 2048
    s_add_u32 s86, s79, 4608
    buffer_load_dwordx4 v3, s[36:39], s86 offen nt lds
    s_add_u32 m0, s87, 3072
    s_add_u32 s86, s79, 23040
    buffer_load_dwordx4 v3, s[36:39], s86 offen nt lds
    s_add_u32 m0, s87, 4096
    s_add_u32 s86, s79, 128
    buffer_load_dwordx4 v3, s[36:39], s86 offen nt lds
    s_add_u32 m0, s87, 5120
    s_add_u32 s86, s79, 18560
    buffer_load_dwordx4 v3, s[36:39], s86 offen nt lds
    s_add_u32 m0, s87, 6144
    s_add_u32 s86, s79, 4736
    buffer_load_dwordx4 v3, s[36:39], s86 offen nt lds
    s_add_u32 m0, s87, 7168
    s_add_u32 s86, s79, 23168
    buffer_load_dwordx4 v3, s[36:39], s86 offen nt lds
    s_add_u32 m0, s87, 8192
    s_add_u32 s86, s79, 256
    buffer_load_dwordx4 v3, s[36:39], s86 offen nt lds
    s_add_u32 m0, s87, 9216
    s_add_u32 s86, s79, 18688
    buffer_load_dwordx4 v3, s[36:39], s86 offen nt lds
    s_add_u32 m0, s87, 10240
    s_add_u32 s86, s79, 4864
    buffer_load_dwordx4 v3, s[36:39], s86 offen nt lds
    s_add_u32 m0, s87, 11264
    s_add_u32 s86, s79, 23296
    buffer_load_dwordx4 v3, s[36:39], s86 offen nt lds
    s_add_u32 m0, s87, 12288
    s_add_u32 s86, s79, 36864
    buffer_load_dwordx4 v3, s[36:39], s86 offen nt lds
    s_add_u32 m0, s87, 13312
    s_add_u32 s86, s79, 55296
    buffer_load_dwordx4 v3, s[36:39], s86 offen nt lds
    s_add_u32 m0, s87, 14336
    s_add_u32 s86, s79, 41472
    buffer_load_dwordx4 v3, s[36:39], s86 offen nt lds
    s_add_u32 m0, s87, 15360
    s_add_u32 s86, s79, 59904
    buffer_load_dwordx4 v3, s[36:39], s86 offen nt lds
    s_add_u32 m0, s87, 16384
    s_add_u32 s86, s79, 36992
    buffer_load_dwordx4 v3, s[36:39], s86 offen nt lds
    s_add_u32 m0, s87, 17408
    s_add_u32 s86, s79, 55424
    buffer_load_dwordx4 v3, s[36:39], s86 offen nt lds
    s_add_u32 m0, s87, 18432
    s_add_u32 s86, s79, 41600
    buffer_load_dwordx4 v3, s[36:39], s86 offen nt lds
    s_add_u32 m0, s87, 19456
    s_add_u32 s86, s79, 60032
    buffer_load_dwordx4 v3, s[36:39], s86 offen nt lds
    s_add_u32 m0, s87, 20480
    s_add_u32 s86, s79, 37120
    buffer_load_dwordx4 v3, s[36:39], s86 offen nt lds
    s_add_u32 m0, s87, 21504
    s_add_u32 s86, s79, 55552
    buffer_load_dwordx4 v3, s[36:39], s86 offen nt lds
    s_add_u32 m0, s87, 22528
    s_add_u32 s86, s79, 41728
    buffer_load_dwordx4 v3, s[36:39], s86 offen nt lds
    s_add_u32 m0, s87, 23552
    s_add_u32 s86, s79, 60160
    buffer_load_dwordx4 v3, s[36:39], s86 offen nt lds
    v_lshrrev_b32 v2, 2, v0
    v_and_b32 v3, 3, v0
    v_lshl_add_u32 v3, v3, 3, s87
    v_lshl_add_u32 v3, v2, 7, v3
    v_bfe_u32 v2, v2, 1, 2
    v_xor_b32 v4, 0, v2
    v_xor_b32 v5, 1, v2
    v_xor_b32 v6, 2, v2
    v_xor_b32 v7, 3, v2
    v_lshl_add_u32 v4, v4, 5, v3
    v_lshl_add_u32 v5, v5, 5, v3
    v_lshl_add_u32 v6, v6, 5, v3
    v_lshl_add_u32 v7, v7, 5, v3
    v_and_b32 v13, 49, v0
    v_and_b32 v12, 12, v0
    v_lshl_add_u32 v12, v13, 1, v12
    v_and_b32 v13, 2, v0
    v_lshl_add_u32 v12, v13, 3, v12
    v_and_b32 v255, 1, v0
    v_lshrrev_b32 v13, 4, v0
    v_lshlrev_b32 v13, 5, v13
    v_lshl_add_u32 v13, v255, 4, v13
    v_mul_u32_u24 v255, 0xaaaa, v255
    v_add_u32 v255, 0x4444, v255
    v_mov_b32 v88, 0
    v_mov_b32 v89, 0
    v_mov_b32 v90, 0
    v_mov_b32 v91, 0
    v_mov_b32 v92, 0
    v_mov_b32 v93, 0
    v_mov_b32 v94, 0
    v_mov_b32 v95, 0
    v_mov_b32 v96, 0
    v_mov_b32 v97, 0
    v_mov_b32 v98, 0
    v_mov_b32 v99, 0
    v_mov_b32 v100, 0
    v_mov_b32 v101, 0
    v_mov_b32 v102, 0
    v_mov_b32 v103, 0
    s_lshl_b32 s86, s33, 7
    s_add_u32 s86, s86, 2048
    v_add_u32 v12, s86, v12
    v_add_u32 v13, s86, v13
    v_lshrrev_b32 v3, 2, v245
    v_mov_b32 v2, 64
    v_cmp_eq_u32 vcc, 0, v3
    s_nop 1
    v_cndmask_b32 v8, v2, v13, vcc
    v_cmp_eq_u32 vcc, 1, v3
    s_nop 1
    v_cndmask_b32 v9, v2, v13, vcc
    v_cmp_eq_u32 vcc, 2, v3
    s_nop 1
    v_cndmask_b32 v10, v2, v13, vcc
    s_mul_i32 s26, s80, 2304
    s_mul_i32 s86, s33, 768
    s_add_u32 s26, s26, s86
    s_add_u32 s26, s26, 393216
    s_lshl_b32 s27, s80, 12
    s_add_u32 s27, s27, 1638400
    v_lshlrev_b32 v13, 4, v244
    ds_read_b32 v2, v1 offset:28
    s_and_b32 s25, s2, 7
    s_mul_i32 s25, s25, 0x500
    s_lshr_b32 s86, s2, 3
    s_mul_i32 s86, s86, 3
    s_add_u32 s86, s86, s33
    s_lshl_b32 s86, s86, 2
    s_add_u32 s25, s25, s86
    s_add_u32 s25, s25, 573224
    v_mov_b32 v11, s35
    s_waitcnt lgkmcnt(0)
    v_readfirstlane_b32 s29, v2
    s_mov_b32 s4, -1
    s_mov_b32 s5, -1
    buffer_load_dwordx4 v[16:19], v14, s[40:43], s27 offen offset:0 sc1 nt
    buffer_load_dwordx4 v[20:23], v14, s[40:43], s27 offen offset:1024 sc1 nt
    buffer_load_dwordx4 v[24:27], v14, s[40:43], s27 offen offset:2048 sc1 nt
    buffer_load_dwordx4 v[28:31], v13, s[40:43], s27 offen offset:3072 sc1 nt
    s_waitcnt vmcnt(24) lgkmcnt(4)
    ds_read_b64_tr_b16 v[116:117], v4 offset:0
    ds_read_b64_tr_b16 v[118:119], v4 offset:2048
    ds_read_b64_tr_b16 v[124:125], v5 offset:0
    ds_read_b64_tr_b16 v[126:127], v5 offset:2048
    ds_read_b64_tr_b16 v[132:133], v6 offset:0
    ds_read_b64_tr_b16 v[134:135], v6 offset:2048
    ds_read_b64_tr_b16 v[140:141], v7 offset:0
    ds_read_b64_tr_b16 v[142:143], v7 offset:2048
    s_waitcnt vmcnt(20) lgkmcnt(4)
    ds_read_b64_tr_b16 v[148:149], v4 offset:4096
    ds_read_b64_tr_b16 v[150:151], v4 offset:6144
    ds_read_b64_tr_b16 v[156:157], v5 offset:4096
    ds_read_b64_tr_b16 v[158:159], v5 offset:6144
    ds_read_b64_tr_b16 v[164:165], v6 offset:4096
    ds_read_b64_tr_b16 v[166:167], v6 offset:6144
    ds_read_b64_tr_b16 v[172:173], v7 offset:4096
    ds_read_b64_tr_b16 v[174:175], v7 offset:6144
    s_waitcnt vmcnt(16) lgkmcnt(4)
    ds_read_b64_tr_b16 v[180:181], v4 offset:8192
    ds_read_b64_tr_b16 v[182:183], v4 offset:10240
    ds_read_b64_tr_b16 v[188:189], v5 offset:8192
    ds_read_b64_tr_b16 v[190:191], v5 offset:10240
    ds_read_b64_tr_b16 v[196:197], v6 offset:8192
    ds_read_b64_tr_b16 v[198:199], v6 offset:10240
    ds_read_b64_tr_b16 v[204:205], v7 offset:8192
    ds_read_b64_tr_b16 v[206:207], v7 offset:10240
    s_waitcnt vmcnt(12) lgkmcnt(4)
    ds_read_b64_tr_b16 v[120:121], v4 offset:12288
    ds_read_b64_tr_b16 v[122:123], v4 offset:14336
    ds_read_b64_tr_b16 v[128:129], v5 offset:12288
    ds_read_b64_tr_b16 v[130:131], v5 offset:14336
    ds_read_b64_tr_b16 v[136:137], v6 offset:12288
    ds_read_b64_tr_b16 v[138:139], v6 offset:14336
    ds_read_b64_tr_b16 v[144:145], v7 offset:12288
    ds_read_b64_tr_b16 v[146:147], v7 offset:14336
    s_waitcnt vmcnt(8) lgkmcnt(4)
    ds_read_b64_tr_b16 v[152:153], v4 offset:16384
    ds_read_b64_tr_b16 v[154:155], v4 offset:18432
    ds_read_b64_tr_b16 v[160:161], v5 offset:16384
    ds_read_b64_tr_b16 v[162:163], v5 offset:18432
    ds_read_b64_tr_b16 v[168:169], v6 offset:16384
    ds_read_b64_tr_b16 v[170:171], v6 offset:18432
    ds_read_b64_tr_b16 v[176:177], v7 offset:16384
    ds_read_b64_tr_b16 v[178:179], v7 offset:18432
    s_waitcnt vmcnt(4) lgkmcnt(4)
    ds_read_b64_tr_b16 v[184:185], v4 offset:20480
    ds_read_b64_tr_b16 v[186:187], v4 offset:22528
    ds_read_b64_tr_b16 v[192:193], v5 offset:20480
    ds_read_b64_tr_b16 v[194:195], v5 offset:22528
    ds_read_b64_tr_b16 v[200:201], v6 offset:20480
    ds_read_b64_tr_b16 v[202:203], v6 offset:22528
    ds_read_b64_tr_b16 v[208:209], v7 offset:20480
    ds_read_b64_tr_b16 v[210:211], v7 offset:22528
    s_branch L_pmc_82
L_pm_80:
    s_mov_b64 exec, s[4:5]
    s_cbranch_execz L_sk_83
    buffer_load_dwordx4 v[16:19], v14, s[40:43], s27 offen offset:0 sc1
    buffer_load_dwordx4 v[20:23], v14, s[40:43], s27 offen offset:1024 sc1
    buffer_load_dwordx4 v[24:27], v14, s[40:43], s27 offen offset:2048 sc1
    buffer_load_dwordx4 v[28:31], v13, s[40:43], s27 offen offset:3072 sc1
L_sk_83:
L_pmc_82:
    s_waitcnt vmcnt(3)
    v_xor_b32 v16, s96, v16
    v_xor_b32 v17, s97, v17
    v_xor_b32 v18, s98, v18
    v_xor_b32 v19, s99, v19
    v_or3_b32 v2, v16, v17, v18
    s_waitcnt vmcnt(2)
    v_xor_b32 v20, s96, v20
    v_xor_b32 v21, s97, v21
    v_xor_b32 v22, s98, v22
    v_xor_b32 v23, s99, v23
    v_or3_b32 v2, v2, v20, v21
    v_or3_b32 v2, v2, v22, v23
    s_waitcnt vmcnt(1)
    v_xor_b32 v24, s96, v24
    v_xor_b32 v25, s97, v25
    v_xor_b32 v26, s98, v26
    v_xor_b32 v27, s99, v27
    v_or3_b32 v2, v2, v24, v25
    v_or3_b32 v2, v2, v26, v27
    s_waitcnt vmcnt(0)
    v_xor_b32 v28, s96, v28
    v_xor_b32 v29, s97, v29
    v_xor_b32 v30, s98, v30
    v_xor_b32 v31, s99, v31
    v_or3_b32 v2, v2, v28, v29
    v_or3_b32 v2, v2, v30, v31
    v_bitop3_b32 v2, v2, v19, v249 bitop3:0x54
    v_cmp_ne_u32 s[4:5], 0, v2
    s_nop 0
    s_wqm_b64 s[4:5], s[4:5]
    s_cbranch_scc0 L_pmd_81
    s_add_u32 s81, s81, 1
    s_cmp_lt_u32 s81, 1048576
    s_cbranch_scc1 L_pm_80
L_pmd_81:
    s_mov_b64 exec, -1
    v_pk_add_f32 v[16:17], v[16:17], v[20:21]
    v_pk_add_f32 v[18:19], v[18:19], v[22:23]
    v_pk_add_f32 v[16:17], v[16:17], v[24:25]
    v_pk_add_f32 v[18:19], v[18:19], v[26:27]
    v_mul_f32 v16, v16, v28
    v_mul_f32 v17, v17, v28
    v_mul_f32 v18, v18, v28
    v_mul_f32 v19, v19, v28
    s_nop 0
    v_permlane32_swap_b32 v16, v18
    v_permlane32_swap_b32 v17, v19
    v_add_f32 v16, v16, v18
    v_add_f32 v17, v17, v19
    s_nop 1
    v_permlane16_swap_b32 v16, v17
    v_add_f32 v16, v16, v17
    v_maximum3_f32 v16, v16, 0, 0
    v_cvt_pk_bf16_f32 v16, v16, v16
    ds_write_b16 v12, v16
    ds_read_b128 v[64:67], v8
    ds_read_b128 v[68:71], v9
    ds_read_b128 v[72:75], v10
    s_waitcnt lgkmcnt(2)
    v_smfmac_f32_16x16x64_bf16 v[88:91], v[64:67], v[116:123], v255
    v_smfmac_f32_16x16x64_bf16 v[92:95], v[64:67], v[124:131], v255
    v_smfmac_f32_16x16x64_bf16 v[96:99], v[64:67], v[132:139], v255
    v_smfmac_f32_16x16x64_bf16 v[100:103], v[64:67], v[140:147], v255
    s_waitcnt lgkmcnt(1)
    v_smfmac_f32_16x16x64_bf16 v[88:91], v[68:71], v[148:155], v255
    v_smfmac_f32_16x16x64_bf16 v[92:95], v[68:71], v[156:163], v255
    v_smfmac_f32_16x16x64_bf16 v[96:99], v[68:71], v[164:171], v255
    v_smfmac_f32_16x16x64_bf16 v[100:103], v[68:71], v[172:179], v255
    s_waitcnt lgkmcnt(0)
    v_smfmac_f32_16x16x64_bf16 v[88:91], v[72:75], v[180:187], v255
    v_smfmac_f32_16x16x64_bf16 v[92:95], v[72:75], v[188:195], v255
    v_smfmac_f32_16x16x64_bf16 v[96:99], v[72:75], v[196:203], v255
    v_smfmac_f32_16x16x64_bf16 v[100:103], v[72:75], v[204:211], v255
    s_nop 4
    v_add_f32 v4, v88, v89
    v_add_f32 v5, v92, v93
    v_add_f32 v6, v96, v97
    v_add_f32 v7, v100, v101
    v_and_or_b32 v4, v4, v249, s96
    v_and_or_b32 v5, v5, v249, s97
    v_and_or_b32 v6, v6, v249, s98
    v_and_or_b32 v7, v7, v249, s99
    s_mov_b32 exec_hi, 0xffff
    buffer_store_dwordx4 v[4:7], v14, s[40:43], s26 offen sc1
    s_mov_b64 exec, 1
    s_cmp_eq_u32 s29, 2
    s_cbranch_scc0 L_far_84
    buffer_store_dword v11, v1, s[40:43], s25 offen offset:0
    s_branch L_std_85
L_far_84:
    buffer_store_dword v11, v1, s[40:43], s25 offen offset:0 sc1
L_std_85:
    s_branch L_exit
L_a_role:
L_wl_86:
    s_sleep 1
    ds_read_b32 v2, v1 offset:28
    s_waitcnt lgkmcnt(0)
    v_cmp_gt_u32 vcc, 1, v2
    s_cbranch_vccnz L_wl_86
    v_readfirstlane_b32 s29, v2
    s_lshl_b32 s27, s80, 12
    s_add_u32 s27, s27, 1638400
    s_cmp_eq_u32 s33, 3
    s_cbranch_scc1 L_a_w3
    s_mov_b32 s36, s64
    s_mov_b32 s37, s65
    s_mov_b32 s38, 5308416
    s_mul_i32 s79, s33, 1769472
    s_lshl_b32 s86, s80, 7
    s_add_u32 s79, s79, s86
    s_lshl_b32 s86, s33, 10
    s_add_u32 s27, s27, s86
    v_bfe_u32 v3, v0, 3, 2
    v_lshrrev_b32 v2, 5, v0
    v_lshl_add_u32 v3, v2, 3, v3
    v_mul_u32_u24 v3, 9216, v3
    s_mul_i32 s87, s33, 24576
    s_add_u32 s87, s87, 28672
    v_lshrrev_b32 v4, 4, v0
    v_lshlrev_b32 v4, 1, v4
    v_xor_b32 v4, v4, v0
    v_and_b32 v4, 7, v4
    v_lshlrev_b32 v2, 4, v4
    v_add_u32 v3, v3, v2
    v_and_b32 v10, 3, v0
    v_lshlrev_b32 v10, 2, v10
L_wp_87:
    s_sleep 1
    ds_read_b32 v9, v10 offset:240
    s_waitcnt lgkmcnt(0)
    v_add_u32_dpp v2, v9, v9 quad_perm:[1,0,3,2] row_mask:0xf bank_mask:0xf
    s_nop 1
    v_add_u32_dpp v2, v2, v2 quad_perm:[2,3,0,1] row_mask:0xf bank_mask:0xf
    s_nop 0
    v_readfirstlane_b32 s8, v2
    s_nop 0
    s_cmp_lt_u32 s8, 832
    s_cbranch_scc1 L_wp_87
    s_add_u32 m0, s87, 0
    s_add_u32 s86, s79, 0
    buffer_load_dwordx4 v3, s[36:39], s86 offen nt lds
    s_add_u32 m0, s87, 1024
    s_add_u32 s86, s79, 147456
    buffer_load_dwordx4 v3, s[36:39], s86 offen nt lds
    s_add_u32 m0, s87, 2048
    s_add_u32 s86, s79, 36864
    buffer_load_dwordx4 v3, s[36:39], s86 offen nt lds
    s_add_u32 m0, s87, 3072
    s_add_u32 s86, s79, 184320
    buffer_load_dwordx4 v3, s[36:39], s86 offen nt lds
    s_add_u32 m0, s87, 4096
    s_add_u32 s86, s79, 294912
    buffer_load_dwordx4 v3, s[36:39], s86 offen nt lds
    s_add_u32 m0, s87, 5120
    s_add_u32 s86, s79, 442368
    buffer_load_dwordx4 v3, s[36:39], s86 offen nt lds
L_wl_88:
    s_sleep 1
    ds_read_b32 v2, v1 offset:236
    s_waitcnt lgkmcnt(0)
    v_cmp_gt_u32 vcc, 1, v2
    s_cbranch_vccnz L_wl_88
    s_add_u32 m0, s87, 6144
    s_add_u32 s86, s79, 331776
    buffer_load_dwordx4 v3, s[36:39], s86 offen nt lds
    s_add_u32 m0, s87, 7168
    s_add_u32 s86, s79, 479232
    buffer_load_dwordx4 v3, s[36:39], s86 offen nt lds
    s_add_u32 m0, s87, 8192
    s_add_u32 s86, s79, 589824
    buffer_load_dwordx4 v3, s[36:39], s86 offen nt lds
    s_add_u32 m0, s87, 9216
    s_add_u32 s86, s79, 737280
    buffer_load_dwordx4 v3, s[36:39], s86 offen nt lds
    s_add_u32 m0, s87, 10240
    s_add_u32 s86, s79, 626688
    buffer_load_dwordx4 v3, s[36:39], s86 offen nt lds
    s_add_u32 m0, s87, 11264
    s_add_u32 s86, s79, 774144
    buffer_load_dwordx4 v3, s[36:39], s86 offen nt lds
    s_add_u32 m0, s87, 12288
    s_add_u32 s86, s79, 884736
    buffer_load_dwordx4 v3, s[36:39], s86 offen nt lds
    s_add_u32 m0, s87, 13312
    s_add_u32 s86, s79, 1032192
    buffer_load_dwordx4 v3, s[36:39], s86 offen nt lds
    s_add_u32 m0, s87, 14336
    s_add_u32 s86, s79, 921600
    buffer_load_dwordx4 v3, s[36:39], s86 offen nt lds
    s_add_u32 m0, s87, 15360
    s_add_u32 s86, s79, 1069056
    buffer_load_dwordx4 v3, s[36:39], s86 offen nt lds
    s_add_u32 m0, s87, 16384
    s_add_u32 s86, s79, 1179648
    buffer_load_dwordx4 v3, s[36:39], s86 offen nt lds
    s_add_u32 m0, s87, 17408
    s_add_u32 s86, s79, 1327104
    buffer_load_dwordx4 v3, s[36:39], s86 offen nt lds
    s_add_u32 m0, s87, 18432
    s_add_u32 s86, s79, 1216512
    buffer_load_dwordx4 v3, s[36:39], s86 offen nt lds
    s_add_u32 m0, s87, 19456
    s_add_u32 s86, s79, 1363968
    buffer_load_dwordx4 v3, s[36:39], s86 offen nt lds
    s_add_u32 m0, s87, 20480
    s_add_u32 s86, s79, 1474560
    buffer_load_dwordx4 v3, s[36:39], s86 offen nt lds
    s_add_u32 m0, s87, 21504
    s_add_u32 s86, s79, 1622016
    buffer_load_dwordx4 v3, s[36:39], s86 offen nt lds
    s_add_u32 m0, s87, 22528
    s_add_u32 s86, s79, 1511424
    buffer_load_dwordx4 v3, s[36:39], s86 offen nt lds
    s_add_u32 m0, s87, 23552
    s_add_u32 s86, s79, 1658880
    buffer_load_dwordx4 v3, s[36:39], s86 offen nt lds
    v_lshrrev_b32 v2, 2, v0
    v_and_b32 v3, 3, v0
    v_lshl_add_u32 v3, v3, 3, s87
    v_lshl_add_u32 v3, v2, 7, v3
    v_bfe_u32 v2, v2, 1, 2
    v_xor_b32 v4, 0, v2
    v_xor_b32 v5, 1, v2
    v_xor_b32 v6, 2, v2
    v_xor_b32 v7, 3, v2
    v_lshl_add_u32 v4, v4, 5, v3
    v_lshl_add_u32 v5, v5, 5, v3
    v_lshl_add_u32 v6, v6, 5, v3
    v_lshl_add_u32 v7, v7, 5, v3
    v_and_b32 v13, 49, v0
    v_and_b32 v12, 12, v0
    v_lshl_add_u32 v12, v13, 1, v12
    v_and_b32 v13, 2, v0
    v_lshl_add_u32 v12, v13, 3, v12
    v_and_b32 v255, 1, v0
    v_lshrrev_b32 v13, 4, v0
    v_lshlrev_b32 v13, 5, v13
    v_lshl_add_u32 v13, v255, 4, v13
    v_mul_u32_u24 v255, 0xaaaa, v255
    v_add_u32 v255, 0x4444, v255
    v_mov_b32 v88, 0
    v_mov_b32 v89, 0
    v_mov_b32 v90, 0
    v_mov_b32 v91, 0
    v_mov_b32 v92, 0
    v_mov_b32 v93, 0
    v_mov_b32 v94, 0
    v_mov_b32 v95, 0
    v_mov_b32 v96, 0
    v_mov_b32 v97, 0
    v_mov_b32 v98, 0
    v_mov_b32 v99, 0
    v_mov_b32 v100, 0
    v_mov_b32 v101, 0
    v_mov_b32 v102, 0
    v_mov_b32 v103, 0
    v_lshrrev_b32 v11, 2, v245
    v_mul_u32_u24 v11, 1216, v11
    s_mul_i32 s86, s33, 384
    s_add_u32 s86, s86, 102400
    v_add_u32 v12, s86, v12
    v_add3_u32 v13, v13, v11, s86
    v_mov_b32 v11, 1
    ds_write_b16_d16_hi v12, v232 offset:1216
    ds_write_b16_d16_hi v12, v228 offset:2432
    ds_write_b16_d16_hi v12, v233 offset:1344
    ds_write_b16_d16_hi v12, v229 offset:2560
    ds_write_b16_d16_hi v12, v234 offset:1472
    ds_write_b16_d16_hi v12, v230 offset:2688
    s_waitcnt vmcnt(20) lgkmcnt(4)
    ds_read_b64_tr_b16 v[116:117], v4 offset:0
    ds_read_b64_tr_b16 v[118:119], v4 offset:2048
    ds_read_b64_tr_b16 v[124:125], v5 offset:0
    ds_read_b64_tr_b16 v[126:127], v5 offset:2048
    ds_read_b64_tr_b16 v[132:133], v6 offset:0
    ds_read_b64_tr_b16 v[134:135], v6 offset:2048
    ds_read_b64_tr_b16 v[140:141], v7 offset:0
    ds_read_b64_tr_b16 v[142:143], v7 offset:2048
    s_waitcnt vmcnt(16) lgkmcnt(4)
    ds_read_b64_tr_b16 v[120:121], v4 offset:4096
    ds_read_b64_tr_b16 v[122:123], v4 offset:6144
    ds_read_b64_tr_b16 v[128:129], v5 offset:4096
    ds_read_b64_tr_b16 v[130:131], v5 offset:6144
    ds_read_b64_tr_b16 v[136:137], v6 offset:4096
    ds_read_b64_tr_b16 v[138:139], v6 offset:6144
    ds_read_b64_tr_b16 v[144:145], v7 offset:4096
    ds_read_b64_tr_b16 v[146:147], v7 offset:6144
    s_waitcnt vmcnt(12) lgkmcnt(4)
    ds_read_b64_tr_b16 v[148:149], v4 offset:8192
    ds_read_b64_tr_b16 v[150:151], v4 offset:10240
    ds_read_b64_tr_b16 v[156:157], v5 offset:8192
    ds_read_b64_tr_b16 v[158:159], v5 offset:10240
    ds_read_b64_tr_b16 v[164:165], v6 offset:8192
    ds_read_b64_tr_b16 v[166:167], v6 offset:10240
    ds_read_b64_tr_b16 v[172:173], v7 offset:8192
    ds_read_b64_tr_b16 v[174:175], v7 offset:10240
    s_waitcnt vmcnt(8) lgkmcnt(4)
    ds_read_b64_tr_b16 v[152:153], v4 offset:12288
    ds_read_b64_tr_b16 v[154:155], v4 offset:14336
    ds_read_b64_tr_b16 v[160:161], v5 offset:12288
    ds_read_b64_tr_b16 v[162:163], v5 offset:14336
    ds_read_b64_tr_b16 v[168:169], v6 offset:12288
    ds_read_b64_tr_b16 v[170:171], v6 offset:14336
    ds_read_b64_tr_b16 v[176:177], v7 offset:12288
    ds_read_b64_tr_b16 v[178:179], v7 offset:14336
    s_waitcnt vmcnt(4) lgkmcnt(4)
    ds_read_b64_tr_b16 v[180:181], v4 offset:16384
    ds_read_b64_tr_b16 v[182:183], v4 offset:18432
    ds_read_b64_tr_b16 v[188:189], v5 offset:16384
    ds_read_b64_tr_b16 v[190:191], v5 offset:18432
    ds_read_b64_tr_b16 v[196:197], v6 offset:16384
    ds_read_b64_tr_b16 v[198:199], v6 offset:18432
    ds_read_b64_tr_b16 v[204:205], v7 offset:16384
    ds_read_b64_tr_b16 v[206:207], v7 offset:18432
    s_waitcnt vmcnt(0) lgkmcnt(4)
    ds_read_b64_tr_b16 v[184:185], v4 offset:20480
    ds_read_b64_tr_b16 v[186:187], v4 offset:22528
    ds_read_b64_tr_b16 v[192:193], v5 offset:20480
    ds_read_b64_tr_b16 v[194:195], v5 offset:22528
    ds_read_b64_tr_b16 v[200:201], v6 offset:20480
    ds_read_b64_tr_b16 v[202:203], v6 offset:22528
    ds_read_b64_tr_b16 v[208:209], v7 offset:20480
    ds_read_b64_tr_b16 v[210:211], v7 offset:22528
    s_mov_b64 exec, 0xff
L_gt_89:
    buffer_load_dwordx2 v[4:5], v254, s[40:43], 0 offen sc1
    s_waitcnt vmcnt(0)
    v_xor_b32 v4, s96, v4
    v_xor_b32 v5, s97, v5
    v_or_b32 v4, v4, v5
    v_and_b32 v4, 0xff, v4
    v_cmp_ne_u32 vcc, 0, v4
    s_nop 0
    s_bcnt1_i32_b64 s86, vcc
    s_cmp_le_u32 s86, 3
    s_cbranch_scc1 L_gtd_90
    s_sleep 3
    s_add_u32 s81, s81, 1
    s_cmp_lt_u32 s81, 1048576
    s_cbranch_scc1 L_gt_89
L_gtd_90:
    s_mov_b32 s4, -1
    s_mov_b32 s5, -1
    s_mov_b32 s6, -1
    s_mov_b32 s7, -1
L_pm_91:
    s_mov_b64 exec, s[4:5]
    s_cbranch_execz L_sk_94
    buffer_load_dwordx4 v[16:19], v252, s[40:43], 0 offen offset:0 sc1
    buffer_load_dwordx4 v[32:35], v252, s[40:43], 0 offen offset:2048 sc1
    buffer_load_dwordx4 v[48:51], v252, s[40:43], s22 offen offset:0 sc1
L_sk_94:
    s_mov_b64 exec, s[6:7]
    s_cbranch_execz L_sk_95
    buffer_load_dwordx4 v[20:23], v252, s[40:43], 0 offen offset:1024 sc1
    buffer_load_dwordx4 v[36:39], v252, s[40:43], 0 offen offset:3072 sc1
    buffer_load_dwordx4 v[52:55], v252, s[40:43], s22 offen offset:1024 sc1
L_sk_95:
L_pmc_93:
    s_mov_b32 s86, 0
    s_waitcnt vmcnt(0)
    s_mov_b64 exec, s[4:5]
    s_cbranch_execz L_sk_96
    v_xor_b32 v16, s96, v16
    v_xor_b32 v17, s97, v17
    v_xor_b32 v18, s98, v18
    v_xor_b32 v19, s99, v19
    v_or3_b32 v2, v16, v17, v18
    v_xor_b32 v32, s96, v32
    v_xor_b32 v33, s97, v33
    v_xor_b32 v34, s98, v34
    v_xor_b32 v35, s99, v35
    v_or3_b32 v2, v2, v32, v33
    v_or3_b32 v2, v2, v34, v35
    v_xor_b32 v48, s96, v48
    v_xor_b32 v49, s97, v49
    v_xor_b32 v50, s98, v50
    v_xor_b32 v51, s99, v51
    v_or3_b32 v2, v2, v48, v49
    v_or3_b32 v2, v2, v50, v51
    v_bitop3_b32 v2, v2, v19, v249 bitop3:0x54
    v_cmp_ne_u32 s[4:5], 0, v2
    s_nop 0
    s_wqm_b64 s[4:5], s[4:5]
    s_addc_u32 s86, s86, 0
L_sk_96:
    s_mov_b64 exec, s[6:7]
    s_cbranch_execz L_sk_97
    v_xor_b32 v20, s96, v20
    v_xor_b32 v21, s97, v21
    v_xor_b32 v22, s98, v22
    v_xor_b32 v23, s99, v23
    v_or3_b32 v2, v20, v21, v22
    v_xor_b32 v36, s96, v36
    v_xor_b32 v37, s97, v37
    v_xor_b32 v38, s98, v38
    v_xor_b32 v39, s99, v39
    v_or3_b32 v2, v2, v36, v37
    v_or3_b32 v2, v2, v38, v39
    v_xor_b32 v52, s96, v52
    v_xor_b32 v53, s97, v53
    v_xor_b32 v54, s98, v54
    v_xor_b32 v55, s99, v55
    v_or3_b32 v2, v2, v52, v53
    v_or3_b32 v2, v2, v54, v55
    v_bitop3_b32 v2, v2, v23, v249 bitop3:0x54
    v_cmp_ne_u32 s[6:7], 0, v2
    s_nop 0
    s_wqm_b64 s[6:7], s[6:7]
    s_addc_u32 s86, s86, 0
L_sk_97:
    s_cmp_eq_u32 s86, 0
    s_cbranch_scc1 L_pmd_92
    s_cmp_eq_u32 s86, 1
    s_cbranch_scc1 L_one_98
    s_add_u32 s81, s81, 1
    s_cmp_lt_u32 s81, 1048576
    s_cbranch_scc1 L_pm_91
    s_branch L_pmd_92
L_one_98:
L_ag_100:
    s_mov_b64 exec, s[4:5]
    s_cbranch_execz L_nx_99
    buffer_load_dwordx4 v[16:19], v252, s[40:43], 0 offen offset:0 sc1
    buffer_load_dwordx4 v[32:35], v252, s[40:43], 0 offen offset:2048 sc1
    buffer_load_dwordx4 v[48:51], v252, s[40:43], s22 offen offset:0 sc1
    s_add_u32 s81, s81, 1
    s_cmp_ge_u32 s81, 1048576
    s_cbranch_scc1 L_pmd_92
    s_waitcnt vmcnt(2)
    v_xor_b32 v16, s96, v16
    v_xor_b32 v17, s97, v17
    v_xor_b32 v18, s98, v18
    v_xor_b32 v19, s99, v19
    v_or3_b32 v2, v16, v17, v18
    s_waitcnt vmcnt(1)
    v_xor_b32 v32, s96, v32
    v_xor_b32 v33, s97, v33
    v_xor_b32 v34, s98, v34
    v_xor_b32 v35, s99, v35
    v_or3_b32 v2, v2, v32, v33
    v_or3_b32 v2, v2, v34, v35
    s_waitcnt vmcnt(0)
    v_xor_b32 v48, s96, v48
    v_xor_b32 v49, s97, v49
    v_xor_b32 v50, s98, v50
    v_xor_b32 v51, s99, v51
    v_or3_b32 v2, v2, v48, v49
    v_or3_b32 v2, v2, v50, v51
    v_bitop3_b32 v2, v2, v19, v249 bitop3:0x54
    v_cmp_ne_u32 s[4:5], 0, v2
    s_nop 0
    s_wqm_b64 s[4:5], s[4:5]
    s_cbranch_scc1 L_ag_100
    s_branch L_pmd_92
L_nx_99:
L_ag_102:
    s_mov_b64 exec, s[6:7]
    s_cbranch_execz L_nx_101
    buffer_load_dwordx4 v[20:23], v252, s[40:43], 0 offen offset:1024 sc1
    buffer_load_dwordx4 v[36:39], v252, s[40:43], 0 offen offset:3072 sc1
    buffer_load_dwordx4 v[52:55], v252, s[40:43], s22 offen offset:1024 sc1
    s_add_u32 s81, s81, 1
    s_cmp_ge_u32 s81, 1048576
    s_cbranch_scc1 L_pmd_92
    s_waitcnt vmcnt(2)
    v_xor_b32 v20, s96, v20
    v_xor_b32 v21, s97, v21
    v_xor_b32 v22, s98, v22
    v_xor_b32 v23, s99, v23
    v_or3_b32 v2, v20, v21, v22
    s_waitcnt vmcnt(1)
    v_xor_b32 v36, s96, v36
    v_xor_b32 v37, s97, v37
    v_xor_b32 v38, s98, v38
    v_xor_b32 v39, s99, v39
    v_or3_b32 v2, v2, v36, v37
    v_or3_b32 v2, v2, v38, v39
    s_waitcnt vmcnt(0)
    v_xor_b32 v52, s96, v52
    v_xor_b32 v53, s97, v53
    v_xor_b32 v54, s98, v54
    v_xor_b32 v55, s99, v55
    v_or3_b32 v2, v2, v52, v53
    v_or3_b32 v2, v2, v54, v55
    v_bitop3_b32 v2, v2, v23, v249 bitop3:0x54
    v_cmp_ne_u32 s[6:7], 0, v2
    s_nop 0
    s_wqm_b64 s[6:7], s[6:7]
    s_cbranch_scc1 L_ag_102
L_nx_101:
L_pmd_92:
    s_mov_b64 exec, -1
    v_pk_add_f32 v[16:17], v[16:17], v[20:21]
    v_pk_add_f32 v[18:19], v[18:19], v[22:23]
    v_pk_add_f32 v[32:33], v[32:33], v[36:37]
    v_pk_add_f32 v[34:35], v[34:35], v[38:39]
    v_pk_add_f32 v[48:49], v[48:49], v[52:53]
    v_pk_add_f32 v[50:51], v[50:51], v[54:55]
    v_permlane32_swap_b32 v16, v18
    v_permlane32_swap_b32 v17, v19
    v_permlane32_swap_b32 v32, v34
    v_permlane32_swap_b32 v33, v35
    v_permlane32_swap_b32 v48, v50
    v_permlane32_swap_b32 v49, v51
    v_add_f32 v16, v16, v18
    v_add_f32 v17, v17, v19
    v_add_f32 v32, v32, v34
    v_add_f32 v33, v33, v35
    v_add_f32 v48, v48, v50
    v_add_f32 v49, v49, v51
    v_permlane16_swap_b32 v16, v17
    v_permlane16_swap_b32 v32, v33
    v_permlane16_swap_b32 v48, v49
    v_add_f32 v16, v16, v17
    v_add_f32 v32, v32, v33
    v_add_f32 v48, v48, v49
    v_cvt_pk_bf16_f32 v4, 0, v16
    v_cvt_pk_bf16_f32 v5, 0, v32
    v_cvt_pk_bf16_f32 v6, 0, v48
    v_mul_f32 v4, v4, v240
    v_mul_f32 v5, v5, v241
    v_mul_f32 v6, v6, v242
    v_cvt_pk_bf16_f32 v4, 0, v4
    v_cvt_pk_bf16_f32 v5, 0, v5
    v_cvt_pk_bf16_f32 v6, 0, v6
    v_add_f32 v4, v4, v236
    v_add_f32 v5, v5, v237
    v_add_f32 v6, v6, v238
    v_cvt_pk_bf16_f32 v4, 0, v4
    v_cvt_pk_bf16_f32 v5, 0, v5
    v_cvt_pk_bf16_f32 v6, 0, v6
    v_mul_f32 v16, v4, v232
    v_mul_f32 v17, v5, v233
    v_mul_f32 v18, v6, v234
    ds_write2st64_b32 v253, v4, v5 offset0:14 offset1:15
    ds_write_b32 v253, v6 offset:4096
    v_cvt_pk_bf16_f32 v20, 0, v16
    v_cvt_pk_bf16_f32 v21, 0, v17
    v_cvt_pk_bf16_f32 v22, 0, v18
    s_mov_b64 exec, 1
    ds_add_u32 v1, v11 offset:228
    s_mov_b64 exec, -1
    v_sub_f32 v16, v16, v20
    v_sub_f32 v17, v17, v21
    v_sub_f32 v18, v18, v22
    ds_write_b16_d16_hi v12, v20 offset:0
    ds_write_b16_d16_hi v12, v21 offset:128
    ds_write_b16_d16_hi v12, v22 offset:256
    ds_write_b16_d16_hi v12, v16 offset:3648
    ds_write_b16_d16_hi v12, v17 offset:3776
    ds_write_b16_d16_hi v12, v18 offset:3904
    ds_read_b128 v[64:67], v13 offset:0
    ds_read_b128 v[68:71], v13 offset:128
    ds_read_b128 v[72:75], v13 offset:256
    s_waitcnt lgkmcnt(2)
    v_smfmac_f32_16x16x64_bf16 v[88:91], v[64:67], v[116:123], v255
    v_smfmac_f32_16x16x64_bf16 v[92:95], v[64:67], v[124:131], v255
    v_smfmac_f32_16x16x64_bf16 v[96:99], v[64:67], v[132:139], v255
    v_smfmac_f32_16x16x64_bf16 v[100:103], v[64:67], v[140:147], v255
    s_waitcnt lgkmcnt(1)
    v_smfmac_f32_16x16x64_bf16 v[88:91], v[68:71], v[148:155], v255
    v_smfmac_f32_16x16x64_bf16 v[92:95], v[68:71], v[156:163], v255
    v_smfmac_f32_16x16x64_bf16 v[96:99], v[68:71], v[164:171], v255
    v_smfmac_f32_16x16x64_bf16 v[100:103], v[68:71], v[172:179], v255
    s_waitcnt lgkmcnt(0)
    v_smfmac_f32_16x16x64_bf16 v[88:91], v[72:75], v[180:187], v255
    v_smfmac_f32_16x16x64_bf16 v[92:95], v[72:75], v[188:195], v255
    v_smfmac_f32_16x16x64_bf16 v[96:99], v[72:75], v[196:203], v255
    v_smfmac_f32_16x16x64_bf16 v[100:103], v[72:75], v[204:211], v255
    s_nop 4
    v_add_f32 v4, v88, v89
    v_add_f32 v5, v92, v93
    v_add_f32 v6, v96, v97
    v_add_f32 v7, v100, v101
    v_and_or_b32 v4, v4, v249, s96
    v_and_or_b32 v5, v5, v249, s97
    v_and_or_b32 v6, v6, v249, s98
    v_and_or_b32 v7, v7, v249, s99
    s_cmp_eq_u32 s29, 2
    s_cbranch_scc0 L_far_103
    buffer_store_dwordx4 v[4:7], v14, s[40:43], s27 offen offset:0
    s_branch L_std_104
L_far_103:
    buffer_store_dwordx4 v[4:7], v14, s[40:43], s27 offen offset:0 sc1
L_std_104:
    s_branch L_exit
L_a_w3:
    v_lshlrev_b32 v13, 2, v0
L_wl_105:
    s_sleep 1
    ds_read_b32 v2, v1 offset:236
    s_waitcnt lgkmcnt(0)
    v_cmp_gt_u32 vcc, 1, v2
    s_cbranch_vccnz L_wl_105
    s_and_b32 s25, s2, 7
    s_mul_i32 s25, s25, 0x500
    s_add_u32 s25, s25, 573440
    buffer_load_dword v11, v1, s[40:43], s25 offen sc1
L_wl_106:
    s_sleep 1
    ds_read_b32 v2, v1 offset:228
    s_waitcnt lgkmcnt(0)
    v_cmp_gt_u32 vcc, 1, v2
    s_cbranch_vccnz L_wl_106
    v_mov_b32 v5, s97
    v_mov_b32 v6, s98
    v_mov_b32 v7, s99
    v_cmp_eq_u32 s[8:9], 61, v0
    v_cmp_eq_u32 s[10:11], 62, v0
L_xwait:
    ds_read_b32 v10, v1 offset:228
    ds_read_b128 v[16:19], v14 offset:3584
    ds_read_b128 v[20:23], v14 offset:4608
    ds_read_b32 v24, v13 offset:5632
    s_waitcnt lgkmcnt(3)
    v_cmp_gt_u32 vcc, 3, v10
    s_cbranch_vccnz L_xwait
    s_waitcnt lgkmcnt(2)
    v_pk_add_f32 v[26:27], v[16:17], v[18:19]
    v_pk_mul_f32 v[28:29], v[16:17], v[16:17]
    v_pk_fma_f32 v[28:29], v[18:19], v[18:19], v[28:29]
    s_waitcnt lgkmcnt(1)
    v_pk_add_f32 v[26:27], v[26:27], v[20:21]
    v_pk_fma_f32 v[28:29], v[20:21], v[20:21], v[28:29]
    v_pk_add_f32 v[26:27], v[26:27], v[22:23]
    v_pk_fma_f32 v[28:29], v[22:23], v[22:23], v[28:29]
    v_add_f32 v2, v26, v27
    v_add_f32 v3, v28, v29
    s_waitcnt lgkmcnt(0)
    v_add_f32 v2, v2, v24
    v_fmac_f32 v3, v24, v24
    s_nop 0
    v_add_f32_dpp v2, v2, v2 quad_perm:[1,0,3,2] row_mask:0xf bank_mask:0xf
    v_add_f32_dpp v3, v3, v3 quad_perm:[1,0,3,2] row_mask:0xf bank_mask:0xf
    s_nop 0
    v_add_f32_dpp v2, v2, v2 quad_perm:[2,3,0,1] row_mask:0xf bank_mask:0xf
    v_add_f32_dpp v3, v3, v3 quad_perm:[2,3,0,1] row_mask:0xf bank_mask:0xf
    s_nop 0
    v_add_f32_dpp v2, v2, v2 row_ror:4 row_mask:0xf bank_mask:0xf
    v_add_f32_dpp v3, v3, v3 row_ror:4 row_mask:0xf bank_mask:0xf
    s_nop 0
    v_add_f32_dpp v2, v2, v2 row_ror:8 row_mask:0xf bank_mask:0xf
    v_add_f32_dpp v3, v3, v3 row_ror:8 row_mask:0xf bank_mask:0xf
    s_nop 0
    v_add_f32_dpp v2, v2, v2 row_bcast:15 row_mask:0xa bank_mask:0xf
    v_add_f32_dpp v3, v3, v3 row_bcast:15 row_mask:0xa bank_mask:0xf
    s_nop 0
    v_add_f32_dpp v2, v2, v2 row_bcast:31 row_mask:0xc bank_mask:0xf
    v_add_f32_dpp v3, v3, v3 row_bcast:31 row_mask:0xc bank_mask:0xf
    v_mul_f32 v2, 0x3ae38e39, v2
    v_mul_f32 v3, 0x3ae38e39, v3
    v_fma_f32 v3, -v2, v2, v3
    v_cvt_pk_bf16_f32 v2, 0, v2
    v_max_f32 v3, 0, v3
    v_cvt_pk_bf16_f32 v3, 0, v3
    v_add_f32 v3, 0x3727c5ac, v3
    v_cvt_pk_bf16_f32 v3, 0, v3
    v_sqrt_f32 v3, v3
    v_cndmask_b32 v2, -1.0, v2, s[8:9]
    v_cvt_pk_bf16_f32 v3, 0, v3
    v_rcp_f32 v3, v3
    s_mov_b32 exec_lo, 0
    s_brev_b32 exec_hi, 15
    v_mul_f32 v4, -v2, v3
    v_cndmask_b32 v4, v4, 1.0, s[10:11]
    v_and_or_b32 v4, v4, v249, s96
    s_cmp_eq_u32 s29, 2
    s_cbranch_scc0 L_far_107
    buffer_store_dwordx4 v[4:7], v14, s[40:43], s27 offen offset:2112
    s_branch L_std_108
L_far_107:
    buffer_store_dwordx4 v[4:7], v14, s[40:43], s27 offen offset:2112 sc1
L_std_108:
    s_mov_b64 exec, -1
    v_add_u32 v1, 15616, v253
    v_and_b32 v8, 0xffffff00, v1
    v_lshl_add_u32 v8, v0, 2, v8
    v_and_b32 v9, 3, v0
    v_lshlrev_b32 v9, 3, v9
    v_bfe_u32 v9, s35, v9, 4
    v_and_b32 v3, 12, v253
    v_lshlrev_b32 v3, 1, v3
    v_bfe_u32 v3, s35, v3, 4
L_pt_109:
    buffer_load_dword v6, v8, s[40:43], 0 offen sc1
    buffer_load_dword v7, v8, s[40:43], s58 offen sc1
    buffer_load_dword v4, v1, s[40:43], 0 offen sc1
    buffer_load_dword v5, v1, s[40:43], s58 offen sc1
    s_waitcnt vmcnt(0)
    v_xor_b32 v6, v9, v6
    v_xor_b32 v7, v9, v7
    v_xor_b32 v4, v3, v4
    v_xor_b32 v5, v3, v5
    v_or_b32 v2, v6, v7
    v_or3_b32 v2, v2, v4, v5
    v_and_b32 v2, 15, v2
    v_cmp_ne_u32 vcc, 0, v2
    s_cbranch_vccz L_ptd_110
    s_sleep 1
    s_add_u32 s81, s81, 1
    s_cmp_lt_u32 s81, 1048576
    s_cbranch_scc1 L_pt_109
L_ptd_110:
    v_add_f32 v4, v4, v5
    v_cvt_pk_bf16_f32 v240, 0, v4
    ds_read_b32 v12, v253 offset:3584
    v_mov_b32 v16, 0
    v_mov_b32 v17, 0
    v_mov_b32 v18, 0
    v_mov_b32 v19, 0
    v_mov_b32 v20, 0
    v_mov_b32 v21, 0
    v_mov_b32 v22, 0
    v_mov_b32 v23, 0
    v_mov_b32 v24, 0
    v_mov_b32 v25, 0
    v_mov_b32 v26, 0
    v_mov_b32 v27, 0
    v_lshrrev_b32 v1, 1, v253
    s_and_b32 s25, s2, 7
    s_mul_i32 s25, s25, 0x500
    s_add_u32 s25, s25, 573440
    s_mov_b64 exec, 0x7ffffff
L_h3gate:
    buffer_load_dword v3, v13, s[40:43], s25 offen sc1
    s_waitcnt vmcnt(0)
    v_cmp_ne_u32 vcc, s35, v3
    s_nop 0
    s_bcnt1_i32_b64 s86, vcc
    s_cmp_le_u32 s86, 0
    s_cbranch_scc1 L_h3go
    s_add_u32 s81, s81, 1
    s_cmp_lt_u32 s81, 1048576
    s_cbranch_scc1 L_h3gate
L_h3go:
    s_mov_b32 s4, -1
    s_mov_b32 s5, 0xffff
    s_mov_b32 s6, -1
    s_mov_b32 s7, 0xffff
    s_mov_b32 s8, -1
    s_mov_b32 s9, 0xffff
L_pm_111:
    s_mov_b64 exec, s[4:5]
    s_cbranch_execz L_sk_114
    buffer_load_dwordx4 v[16:19], v252, s[40:43], 0 offen sc1
L_sk_114:
    s_mov_b64 exec, s[6:7]
    s_cbranch_execz L_sk_115
    buffer_load_dwordx4 v[20:23], v252, s[40:43], s22 offen sc1
L_sk_115:
    s_mov_b64 exec, s[8:9]
    s_cbranch_execz L_sk_116
    buffer_load_dwordx4 v[24:27], v252, s[40:43], s23 offen sc1
L_sk_116:
L_pmc_113:
    s_mov_b32 s86, 0
    s_waitcnt vmcnt(0)
    s_mov_b64 exec, s[4:5]
    s_cbranch_execz L_sk_117
    v_xor_b32 v16, s96, v16
    v_xor_b32 v17, s97, v17
    v_xor_b32 v18, s98, v18
    v_xor_b32 v19, s99, v19
    v_or3_b32 v2, v16, v17, v18
    v_bitop3_b32 v2, v2, v19, v249 bitop3:0x54
    v_cmp_ne_u32 s[4:5], 0, v2
    s_nop 0
    s_wqm_b64 s[4:5], s[4:5]
    s_addc_u32 s86, s86, 0
L_sk_117:
    s_mov_b64 exec, s[6:7]
    s_cbranch_execz L_sk_118
    v_xor_b32 v20, s96, v20
    v_xor_b32 v21, s97, v21
    v_xor_b32 v22, s98, v22
    v_xor_b32 v23, s99, v23
    v_or3_b32 v2, v20, v21, v22
    v_bitop3_b32 v2, v2, v23, v249 bitop3:0x54
    v_cmp_ne_u32 s[6:7], 0, v2
    s_nop 0
    s_wqm_b64 s[6:7], s[6:7]
    s_addc_u32 s86, s86, 0
L_sk_118:
    s_mov_b64 exec, s[8:9]
    s_cbranch_execz L_sk_119
    v_xor_b32 v24, s96, v24
    v_xor_b32 v25, s97, v25
    v_xor_b32 v26, s98, v26
    v_xor_b32 v27, s99, v27
    v_or3_b32 v2, v24, v25, v26
    v_bitop3_b32 v2, v2, v27, v249 bitop3:0x54
    v_cmp_ne_u32 s[8:9], 0, v2
    s_nop 0
    s_wqm_b64 s[8:9], s[8:9]
    s_addc_u32 s86, s86, 0
L_sk_119:
    s_cmp_eq_u32 s86, 0
    s_cbranch_scc1 L_pmd_112
    s_cmp_eq_u32 s86, 1
    s_cbranch_scc1 L_one_120
    s_add_u32 s81, s81, 1
    s_cmp_lt_u32 s81, 1048576
    s_cbranch_scc1 L_pm_111
    s_branch L_pmd_112
L_one_120:
L_ag_122:
    s_mov_b64 exec, s[4:5]
    s_cbranch_execz L_nx_121
    buffer_load_dwordx4 v[16:19], v252, s[40:43], 0 offen sc1
    s_add_u32 s81, s81, 1
    s_cmp_ge_u32 s81, 1048576
    s_cbranch_scc1 L_pmd_112
    s_waitcnt vmcnt(0)
    v_xor_b32 v16, s96, v16
    v_xor_b32 v17, s97, v17
    v_xor_b32 v18, s98, v18
    v_xor_b32 v19, s99, v19
    v_or3_b32 v2, v16, v17, v18
    v_bitop3_b32 v2, v2, v19, v249 bitop3:0x54
    v_cmp_ne_u32 s[4:5], 0, v2
    s_nop 0
    s_wqm_b64 s[4:5], s[4:5]
    s_cbranch_scc1 L_ag_122
    s_branch L_pmd_112
L_nx_121:
L_ag_124:
    s_mov_b64 exec, s[6:7]
    s_cbranch_execz L_nx_123
    buffer_load_dwordx4 v[20:23], v252, s[40:43], s22 offen sc1
    s_add_u32 s81, s81, 1
    s_cmp_ge_u32 s81, 1048576
    s_cbranch_scc1 L_pmd_112
    s_waitcnt vmcnt(0)
    v_xor_b32 v20, s96, v20
    v_xor_b32 v21, s97, v21
    v_xor_b32 v22, s98, v22
    v_xor_b32 v23, s99, v23
    v_or3_b32 v2, v20, v21, v22
    v_bitop3_b32 v2, v2, v23, v249 bitop3:0x54
    v_cmp_ne_u32 s[6:7], 0, v2
    s_nop 0
    s_wqm_b64 s[6:7], s[6:7]
    s_cbranch_scc1 L_ag_124
    s_branch L_pmd_112
L_nx_123:
L_ag_126:
    s_mov_b64 exec, s[8:9]
    s_cbranch_execz L_nx_125
    buffer_load_dwordx4 v[24:27], v252, s[40:43], s23 offen sc1
    s_add_u32 s81, s81, 1
    s_cmp_ge_u32 s81, 1048576
    s_cbranch_scc1 L_pmd_112
    s_waitcnt vmcnt(0)
    v_xor_b32 v24, s96, v24
    v_xor_b32 v25, s97, v25
    v_xor_b32 v26, s98, v26
    v_xor_b32 v27, s99, v27
    v_or3_b32 v2, v24, v25, v26
    v_bitop3_b32 v2, v2, v27, v249 bitop3:0x54
    v_cmp_ne_u32 s[8:9], 0, v2
    s_nop 0
    s_wqm_b64 s[8:9], s[8:9]
    s_cbranch_scc1 L_ag_126
L_nx_125:
L_pmd_112:
    s_mov_b64 exec, -1
    v_add_f32 v16, v16, v20
    v_add_f32 v17, v17, v21
    v_add_f32 v18, v18, v22
    v_add_f32 v19, v19, v23
    v_add_f32 v16, v16, v24
    v_add_f32 v17, v17, v25
    v_add_f32 v18, v18, v26
    v_add_f32 v19, v19, v27
    s_nop 0
    v_permlane32_swap_b32 v16, v18
    v_permlane32_swap_b32 v17, v19
    v_add_f32 v16, v16, v18
    v_add_f32 v17, v17, v19
    s_nop 1
    v_permlane16_swap_b32 v16, v17
    v_add_f32 v16, v16, v17
    s_nop 1
    v_add_f32_dpp v16, v16, v16 quad_perm:[2,3,0,1] row_mask:0xf bank_mask:0xf
    s_nop 1
    v_add_f32_dpp v16, v16, v16 row_ror:4 row_mask:0xf bank_mask:0xf
    s_nop 1
    v_add_f32_dpp v16, v16, v16 row_ror:8 row_mask:0xf bank_mask:0xf
    v_cvt_pk_bf16_f32 v4, 0, v16
    v_mul_f32 v4, v4, v240
    v_cvt_pk_bf16_f32 v4, 0, v4
    s_waitcnt lgkmcnt(0)
    v_add_f32 v4, v4, v12
    v_cvt_pk_bf16_f32 v4, v4, v4
    s_mov_b32 exec_lo, 0x00030003
    s_mov_b32 exec_hi, 0x00030003
    buffer_store_short v4, v1, s[48:51], 0 offen
    s_cmp_lg_u32 s80, 0
    s_cbranch_scc1 L_noep
    s_mov_b64 exec, 1
    v_mov_b32 v5, s35
    buffer_store_dword v5, v14, s[40:43], 0 offen offset:0
L_noep:
L_exit:
L_end:
    s_endpgm
.fill 64, 4, 0xbf800000
.section .rodata,"a"
.p2align 6
.amdhsa_kernel adaLN_cond__gqa_block_cached__dense_activation_relu__decode_kernel
  .amdhsa_next_free_vgpr 256
  .amdhsa_next_free_sgpr 102
  .amdhsa_accum_offset 256
  .amdhsa_group_segment_fixed_size 0
  .amdhsa_kernarg_size 104
  .amdhsa_user_sgpr_count 2
  .amdhsa_user_sgpr_kernarg_segment_ptr 1
  .amdhsa_system_sgpr_workgroup_id_x 1
  .amdhsa_float_denorm_mode_32 3
.end_amdhsa_kernel
```
